```python
import torch

def _softmax(x, axis=-1):
    return torch.softmax(x, dim=axis)
def _gelu(x):
    return torch.nn.functional.gelu(x, approximate="tanh")
def _silu(x):
    return torch.nn.functional.silu(x)
def _sigmoid(x):
    return torch.sigmoid(x)
def _layernorm(x, axis=-1, eps=1e-5):
    m = x.mean(dim=axis, keepdim=True)
    v = x.var(dim=axis, keepdim=True, unbiased=False)
    return (x - m) / torch.sqrt(v + eps)
def _scatter_add(tgt, idx, src, axis=0):
    return tgt.clone().index_add_(axis, idx, src)
def _segment_sum(src, seg, n):
    out = torch.zeros((n,) + src.shape[1:], dtype=src.dtype)
    return out.index_add_(0, seg, src)
def _pad(x, pw):
    flat = tuple(v for pair in reversed(pw) for v in pair)
    return torch.nn.functional.pad(x, flat)

kernel_name = 'standalone__structured_sparse_n_m__ragged'

def setup_inputs():

    _w = (lambda a: (lambda t: t.to(torch.bfloat16) if t.is_floating_point() else t)(torch.as_tensor(a)))
    B, S, D = 4, 2048, 640
    assert D % 4 == 0, "d_model must be divisible by M=4 for 2:4 sparsity"
    return {
        "x": _w((lambda *s: torch.randn(*s, dtype=torch.bfloat16) * 0.05)(B, S, D)),
        "w": _w((lambda *s: torch.randn(*s, dtype=torch.bfloat16) * 0.05)(D, D)),
        "b": _w((lambda *s: torch.randn(*s, dtype=torch.bfloat16) * 0.05)(D)),
    }

def reference(x, w, b):
    B, S, D = x.shape
    N, M = 2, 4
    G = D // M
    wg = w.reshape(G, M, D)
    mag = torch.abs(wg)
    order = torch.argsort(mag, 1)
    thr = (lambda x, i, axis: torch.take_along_dim(x, i, dim=axis))(mag, order[:, M - N:M - N + 1, :], 1)
    mask = (lambda x, dt: x.to(dt))(mag >= thr, w.dtype)
    wp = (wg * mask).reshape(D, D)
    return torch.einsum("bsd,df->bsf", x, wp) + b
```

```asm
; @launch grid=(256,1,1) block=(512,1,1) lds=148480
.amdgcn_target "amdgcn-amd-amdhsa--gfx950"
.text
.globl standalone__structured_sparse_n_m__ragged_kernel
.p2align 8
.type standalone__structured_sparse_n_m__ragged_kernel,@function
standalone__structured_sparse_n_m__ragged_kernel:
    s_cmpk_ge_u32 s2, 256
    s_cbranch_scc1 L_end
    s_load_dwordx2 s[8:9], s[0:1], 8
    s_load_dwordx2 s[4:5], s[0:1], 0
    s_load_dwordx2 s[16:17], s[0:1], 16
    s_load_dwordx2 s[12:13], s[0:1], 24
    v_lshrrev_b32 v7, 4, v0
    v_lshrrev_b32 v1, 6, v0
    v_and_b32 v0, 63, v0
    v_readfirstlane_b32 s28, v1
    s_lshr_b32 s29, s2, 3
    s_lshr_b32 s30, s29, 2
    s_and_b32 s29, s29, 3
    s_mov_b32 s31, 0
    s_and_b32 s34, s29, 1
    s_mulk_i32 s29, 320
    s_lshl_b32 s35, s34, 6
    s_add_u32 s32, s29, s35
    s_xor_b32 s34, s34, 1
    s_lshl_b32 s34, s34, 8
    s_add_u32 s33, s29, s34
    s_and_b32 s38, s28, 3
    v_lshrrev_b32 v2, 3, v0
    v_and_b32 v3, 7, v0
    s_and_b32 s34, s38, 1
    s_lshr_b32 s35, s38, 1
    s_mul_i32 s39, s34, 40960
    s_lshl_b32 s40, s35, 7
    s_add_u32 s39, s39, s40
    s_add_u32 s39, s39, s32
    v_mul_u32_u24 v4, 5120, v2
    v_lshl_add_u32 v4, v3, 4, v4
    v_add_u32 v8, s39, v4
    s_mov_b32 s10, 819200
    s_mov_b32 s11, 0x20000
    s_lshr_b32 s42, s28, 2
    s_sub_u32 s42, s31, s42
    s_add_u32 s42, s42, 1
    s_cmp_lg_u32 s42, 10
    s_cselect_b32 s42, s42, 0
    s_mul_i32 s42, s42, 81920
    s_waitcnt lgkmcnt(0)
    buffer_load_dwordx4 v[144:147], v8, s[8:11], s42 offen offset:0
    buffer_load_dwordx4 v[148:151], v8, s[8:11], s42 offen offset:1280
    buffer_load_dwordx4 v[152:155], v8, s[8:11], s42 offen offset:2560
    buffer_load_dwordx4 v[156:159], v8, s[8:11], s42 offen offset:3840
    s_getpc_b64 s[36:37]
L_pc:
    s_lshr_b32 s39, s2, 3
    s_mul_i32 s39, s39, 5
    v_add_u32 v7, s39, v7
    v_subrev_u32 v5, 160, v7
    v_min_u32 v7, v5, v7
    v_lshlrev_b32 v7, 7, v7
    v_min_u32 v7, L_end-L_pc, v7
    global_load_dword v142, v7, s[36:37]
    s_lshl_b32 s35, s35, 13
    s_lshl_b32 s34, s34, 11
    s_add_u32 s34, s34, s35
    v_bfe_u32 v5, v0, 2, 1
    v_mul_u32_u24 v5, 4160, v5
    v_lshl_add_u32 v5, v2, 8, v5
    v_and_b32 v6, 3, v0
    v_lshl_add_u32 v5, v6, 4, v5
    v_add_u32 v9, s34, v5
    v_xor_b32 v10, 64, v9
    s_cmp_ge_u32 s28, 4
    s_cbranch_scc1 L_prod
    s_lshl_b32 s41, s31, 7
    s_and_b32 s34, s2, 7
    s_lshl_b32 s34, s34, 3
    s_add_u32 s34, s34, s30
    s_lshl_b32 s34, s34, 2
    s_add_u32 s34, s34, s38
    s_mul_i32 s34, s34, 40960
    v_lshrrev_b32 v4, 4, v0
    v_xor_b32 v4, v4, v3
    v_mul_u32_u24 v5, 1280, v2
    v_lshl_add_u32 v5, v4, 4, v5
    v_add_u32 v254, s34, v5
    v_xor_b32 v255, 64, v254
    s_mov_b32 s6, 10485760
    s_mov_b32 s7, 0x20000
    s_mul_i32 s43, s38, 24576
    s_add_u32 s43, s43, 50176
    s_mov_b32 m0, s43
    s_add_u32 s45, s41, 9216
    s_add_u32 s46, s41, 18432
    s_add_u32 s47, s41, 27648
    buffer_load_dwordx4 v254, s[4:7], s41 offen offset:0 lds
    buffer_load_dwordx4 v255, s[4:7], s45 offen offset:1024 lds
    buffer_load_dwordx4 v254, s[4:7], s46 offen offset:2048 lds
    buffer_load_dwordx4 v255, s[4:7], s47 offen offset:3072 lds
    s_addk_i32 s41, 128
    s_cmpk_lg_u32 s41, 1280
    s_cselect_b32 s41, s41, 0
    v_and_b32 v4, 31, v0
    v_lshrrev_b32 v5, 5, v0
    v_bfe_u32 v6, v0, 1, 3
    v_xor_b32 v6, v6, v5
    v_lshlrev_b32 v6, 4, v6
    v_lshl_add_u32 v6, v4, 7, v6
    v_add_u32 v250, s43, v6
    v_xor_b32 v251, 32, v250
    v_xor_b32 v252, 64, v250
    v_xor_b32 v253, 96, v250
    v_lshlrev_b32 v6, 9, v5
    v_bfe_u32 v7, v0, 2, 2
    v_lshl_add_u32 v6, v7, 6, v6
    v_bfe_u32 v7, v0, 4, 1
    v_lshl_add_u32 v6, v7, 5, v6
    v_and_b32 v7, 3, v0
    v_lshl_add_u32 v248, v7, 3, v6
    v_xor_b32 v249, 64, v248
    v_lshlrev_b32 v143, 4, v5
    v_add_u32 v143, 49152, v143
    v_mov_b32 v128, 0x7fff7fff
    s_mov_b32 s14, 10485760
    s_mov_b32 s15, 0x20000
    s_waitcnt vmcnt(5)
    v_and_b32 v112, v128, v144
    v_and_b32 v113, v128, v148
    v_and_b32 v114, v128, v152
    v_and_b32 v115, v128, v156
    s_add_u32 m0, s43, 4096
    s_add_u32 s45, s41, 9216
    s_add_u32 s46, s41, 18432
    s_add_u32 s47, s41, 27648
    buffer_load_dwordx4 v254, s[4:7], s41 offen offset:0 lds
    v_and_b32 v120, v128, v145
    v_and_b32 v121, v128, v149
    v_and_b32 v122, v128, v153
    v_and_b32 v123, v128, v157
    v_pk_max_u16 v116, v112, v113
    v_pk_max_u16 v124, v120, v121
    v_pk_min_u16 v117, v112, v113
    v_pk_min_u16 v125, v120, v121
    v_pk_max_u16 v118, v114, v115
    v_pk_max_u16 v126, v122, v123
    buffer_load_dwordx4 v255, s[4:7], s45 offen offset:1024 lds
    v_pk_min_u16 v119, v114, v115
    v_pk_min_u16 v127, v122, v123
    v_pk_max_u16 v116, v116, v119
    v_pk_max_u16 v124, v124, v127
    v_pk_max_u16 v118, v118, v117
    v_pk_max_u16 v126, v126, v125
    v_pk_min_u16 v116, v116, v118
    v_pk_min_u16 v124, v124, v126
    v_pk_sub_i16 v112, v112, v116
    v_pk_sub_i16 v120, v120, v124
    buffer_load_dwordx4 v254, s[4:7], s46 offen offset:2048 lds
    v_pk_sub_i16 v113, v113, v116
    v_pk_sub_i16 v121, v121, v124
    v_pk_sub_i16 v114, v114, v116
    v_pk_sub_i16 v122, v122, v124
    v_pk_sub_i16 v115, v115, v116
    v_pk_sub_i16 v123, v123, v124
    v_pk_ashrrev_i16 v112, 15, v112 op_sel_hi:[0,1]
    v_pk_ashrrev_i16 v120, 15, v120 op_sel_hi:[0,1]
    v_pk_ashrrev_i16 v113, 15, v113 op_sel_hi:[0,1]
    v_pk_ashrrev_i16 v121, 15, v121 op_sel_hi:[0,1]
    buffer_load_dwordx4 v255, s[4:7], s47 offen offset:3072 lds
    s_addk_i32 s41, 128
    s_cmpk_lg_u32 s41, 1280
    s_cselect_b32 s41, s41, 0
    s_nop 0
    v_pk_ashrrev_i16 v114, 15, v114 op_sel_hi:[0,1]
    v_pk_ashrrev_i16 v122, 15, v122 op_sel_hi:[0,1]
    v_pk_ashrrev_i16 v115, 15, v115 op_sel_hi:[0,1]
    v_pk_ashrrev_i16 v123, 15, v123 op_sel_hi:[0,1]
    v_bitop3_b32 v144, v144, v112, v112 bitop3:0x30
    v_bitop3_b32 v145, v145, v120, v120 bitop3:0x30
    v_bitop3_b32 v148, v148, v113, v113 bitop3:0x30
    v_bitop3_b32 v149, v149, v121, v121 bitop3:0x30
    v_bitop3_b32 v152, v152, v114, v114 bitop3:0x30
    v_bitop3_b32 v153, v153, v122, v122 bitop3:0x30
    v_bitop3_b32 v156, v156, v115, v115 bitop3:0x30
    v_bitop3_b32 v157, v157, v123, v123 bitop3:0x30
    s_add_u32 m0, s43, 8192
    s_add_u32 s45, s41, 9216
    s_add_u32 s46, s41, 18432
    s_add_u32 s47, s41, 27648
    buffer_load_dwordx4 v254, s[4:7], s41 offen offset:0 lds
    v_and_b32 v112, v128, v146
    v_and_b32 v113, v128, v150
    v_and_b32 v114, v128, v154
    v_and_b32 v115, v128, v158
    v_and_b32 v120, v128, v147
    v_and_b32 v121, v128, v151
    v_and_b32 v122, v128, v155
    v_and_b32 v123, v128, v159
    v_pk_max_u16 v116, v112, v113
    v_pk_max_u16 v124, v120, v121
    buffer_load_dwordx4 v255, s[4:7], s45 offen offset:1024 lds
    v_pk_min_u16 v117, v112, v113
    v_pk_min_u16 v125, v120, v121
    v_pk_max_u16 v118, v114, v115
    v_pk_max_u16 v126, v122, v123
    v_pk_min_u16 v119, v114, v115
    v_pk_min_u16 v127, v122, v123
    v_pk_max_u16 v116, v116, v119
    v_pk_max_u16 v124, v124, v127
    v_pk_max_u16 v118, v118, v117
    v_pk_max_u16 v126, v126, v125
    buffer_load_dwordx4 v254, s[4:7], s46 offen offset:2048 lds
    v_pk_min_u16 v116, v116, v118
    v_pk_min_u16 v124, v124, v126
    v_pk_sub_i16 v112, v112, v116
    v_pk_sub_i16 v120, v120, v124
    v_pk_sub_i16 v113, v113, v116
    v_pk_sub_i16 v121, v121, v124
    v_pk_sub_i16 v114, v114, v116
    v_pk_sub_i16 v122, v122, v124
    v_pk_sub_i16 v115, v115, v116
    v_pk_sub_i16 v123, v123, v124
    buffer_load_dwordx4 v255, s[4:7], s47 offen offset:3072 lds
    s_addk_i32 s41, 128
    s_cmpk_lg_u32 s41, 1280
    s_cselect_b32 s41, s41, 0
    s_nop 0
    v_pk_ashrrev_i16 v112, 15, v112 op_sel_hi:[0,1]
    v_pk_ashrrev_i16 v120, 15, v120 op_sel_hi:[0,1]
    v_pk_ashrrev_i16 v113, 15, v113 op_sel_hi:[0,1]
    v_pk_ashrrev_i16 v121, 15, v121 op_sel_hi:[0,1]
    v_pk_ashrrev_i16 v114, 15, v114 op_sel_hi:[0,1]
    v_pk_ashrrev_i16 v122, 15, v122 op_sel_hi:[0,1]
    v_pk_ashrrev_i16 v115, 15, v115 op_sel_hi:[0,1]
    v_pk_ashrrev_i16 v123, 15, v123 op_sel_hi:[0,1]
    v_bitop3_b32 v146, v146, v112, v112 bitop3:0x30
    v_bitop3_b32 v147, v147, v120, v120 bitop3:0x30
    v_bitop3_b32 v150, v150, v113, v113 bitop3:0x30
    v_bitop3_b32 v151, v151, v121, v121 bitop3:0x30
    v_bitop3_b32 v154, v154, v114, v114 bitop3:0x30
    v_bitop3_b32 v155, v155, v122, v122 bitop3:0x30
    v_bitop3_b32 v158, v158, v115, v115 bitop3:0x30
    v_bitop3_b32 v159, v159, v123, v123 bitop3:0x30
    ds_write_b128 v9, v[144:147] offset:16384
    ds_write_b128 v10, v[148:151] offset:16384
    ds_write_b128 v9, v[152:155] offset:16512
    ds_write_b128 v10, v[156:159] offset:16512
    s_waitcnt vmcnt(8)
    s_nop 0
    ds_read_b128 v[0:3], v250 offset:0
    ds_read_b128 v[4:7], v251 offset:0
    ds_read_b128 v[8:11], v252 offset:0
    ds_read_b128 v[12:15], v253 offset:0
    s_waitcnt lgkmcnt(0)
    s_barrier
    ds_read_b128 v[160:163], v143 offset:0
    ds_read_b128 v[164:167], v143 offset:32
    ds_read_b128 v[168:171], v143 offset:64
    ds_read_b128 v[172:175], v143 offset:96
    ds_read_b64_tr_b16 v[224:225], v248 offset:0
    ds_read_b64_tr_b16 v[226:227], v248 offset:256
    ds_read_b64_tr_b16 v[228:229], v248 offset:1024
    ds_read_b64_tr_b16 v[230:231], v248 offset:1280
    ds_read_b64_tr_b16 v[232:233], v248 offset:2048
    ds_read_b64_tr_b16 v[234:235], v248 offset:2304
    ds_read_b64_tr_b16 v[236:237], v248 offset:3072
    ds_read_b64_tr_b16 v[238:239], v248 offset:3328
    ds_read_b64_tr_b16 v[240:241], v249 offset:4096
    ds_read_b64_tr_b16 v[242:243], v249 offset:4352
    ds_read_b64_tr_b16 v[244:245], v249 offset:5120
    ds_read_b64_tr_b16 v[246:247], v249 offset:5376
    s_waitcnt lgkmcnt(10)
    s_nop 0
    v_mfma_f32_32x32x16_bf16 v[160:175], v[224:227], v[0:3], v[160:175]
    ds_read_b64_tr_b16 v[224:225], v249 offset:6144
    ds_read_b64_tr_b16 v[226:227], v249 offset:6400
    ds_read_b128 v[176:179], v143 offset:128
    ds_read_b128 v[180:183], v143 offset:160
    ds_read_b128 v[184:187], v143 offset:192
    s_waitcnt lgkmcnt(13)
    s_nop 0
    v_mfma_f32_32x32x16_bf16 v[160:175], v[228:231], v[4:7], v[160:175]
    ds_read_b64_tr_b16 v[228:229], v249 offset:7168
    ds_read_b64_tr_b16 v[230:231], v249 offset:7424
    ds_read_b128 v[188:191], v143 offset:224
    ds_read_b128 v[192:195], v143 offset:256
    ds_read_b128 v[196:199], v143 offset:288
    s_waitcnt lgkmcnt(15)
    s_nop 0
    v_mfma_f32_32x32x16_bf16 v[160:175], v[232:235], v[8:11], v[160:175]
    ds_read_b64_tr_b16 v[232:233], v248 offset:8192
    ds_read_b64_tr_b16 v[234:235], v248 offset:8448
    ds_read_b128 v[200:203], v143 offset:320
    ds_read_b128 v[204:207], v143 offset:352
    ds_read_b128 v[208:211], v143 offset:384
    s_waitcnt lgkmcnt(15)
    s_nop 0
    v_mfma_f32_32x32x16_bf16 v[160:175], v[236:239], v[12:15], v[160:175]
    ds_read_b64_tr_b16 v[236:237], v248 offset:9216
    ds_read_b64_tr_b16 v[238:239], v248 offset:9472
    ds_read_b128 v[212:215], v143 offset:416
    ds_read_b128 v[216:219], v143 offset:448
    ds_read_b128 v[220:223], v143 offset:480
    s_waitcnt lgkmcnt(12)
    s_nop 0
    v_mfma_f32_32x32x16_bf16 v[176:191], v[240:243], v[0:3], v[176:191]
    ds_read_b64_tr_b16 v[240:241], v248 offset:10240
    ds_read_b64_tr_b16 v[242:243], v248 offset:10496
    s_add_u32 m0, s43, 12288
    s_add_u32 s45, s41, 9216
    s_add_u32 s46, s41, 18432
    v_mfma_f32_32x32x16_bf16 v[176:191], v[244:247], v[4:7], v[176:191]
    ds_read_b64_tr_b16 v[244:245], v248 offset:11264
    ds_read_b64_tr_b16 v[246:247], v248 offset:11520
    s_add_u32 s47, s41, 27648
    buffer_load_dwordx4 v254, s[4:7], s41 offen offset:0 lds
    buffer_load_dwordx4 v255, s[4:7], s45 offen offset:1024 lds
    v_mfma_f32_32x32x16_bf16 v[176:191], v[224:227], v[8:11], v[176:191]
    ds_read_b64_tr_b16 v[224:225], v249 offset:12288
    ds_read_b64_tr_b16 v[226:227], v249 offset:12544
    s_waitcnt vmcnt(6)
    s_nop 0
    ds_read_b128 v[16:19], v250 offset:4096
    ds_read_b128 v[20:23], v251 offset:4096
    v_mfma_f32_32x32x16_bf16 v[176:191], v[228:231], v[12:15], v[176:191]
    ds_read_b64_tr_b16 v[228:229], v249 offset:13312
    ds_read_b64_tr_b16 v[230:231], v249 offset:13568
    ds_read_b128 v[24:27], v252 offset:4096
    ds_read_b128 v[28:31], v253 offset:4096
    s_waitcnt lgkmcnt(15)
    s_nop 0
    v_mfma_f32_32x32x16_bf16 v[192:207], v[232:235], v[0:3], v[192:207]
    ds_read_b64_tr_b16 v[232:233], v249 offset:14336
    ds_read_b64_tr_b16 v[234:235], v249 offset:14592
    v_mfma_f32_32x32x16_bf16 v[192:207], v[236:239], v[4:7], v[192:207]
    ds_read_b64_tr_b16 v[236:237], v249 offset:15360
    ds_read_b64_tr_b16 v[238:239], v249 offset:15616
    buffer_load_dwordx4 v254, s[4:7], s46 offen offset:2048 lds
    s_waitcnt lgkmcnt(14)
    s_nop 0
    v_mfma_f32_32x32x16_bf16 v[192:207], v[240:243], v[8:11], v[192:207]
    s_barrier
    s_nop 0
    ds_read_b64_tr_b16 v[240:241], v248 offset:16384
    ds_read_b64_tr_b16 v[242:243], v248 offset:16640
    s_waitcnt lgkmcnt(14)
    s_nop 0
    v_mfma_f32_32x32x16_bf16 v[192:207], v[244:247], v[12:15], v[192:207]
    ds_read_b64_tr_b16 v[244:245], v248 offset:17408
    ds_read_b64_tr_b16 v[246:247], v248 offset:17664
    s_waitcnt lgkmcnt(14)
    s_nop 0
    v_mfma_f32_32x32x16_bf16 v[208:223], v[224:227], v[0:3], v[208:223]
    ds_read_b64_tr_b16 v[224:225], v248 offset:18432
    ds_read_b64_tr_b16 v[226:227], v248 offset:18688
    s_waitcnt lgkmcnt(12)
    s_nop 0
    v_mfma_f32_32x32x16_bf16 v[208:223], v[228:231], v[4:7], v[208:223]
    ds_read_b64_tr_b16 v[228:229], v248 offset:19456
    ds_read_b64_tr_b16 v[230:231], v248 offset:19712
    buffer_load_dwordx4 v255, s[4:7], s47 offen offset:3072 lds
    s_addk_i32 s41, 128
    s_cmpk_lg_u32 s41, 1280
    s_waitcnt lgkmcnt(10)
    s_nop 0
    v_mfma_f32_32x32x16_bf16 v[208:223], v[232:235], v[8:11], v[208:223]
    ds_read_b64_tr_b16 v[232:233], v249 offset:20480
    ds_read_b64_tr_b16 v[234:235], v249 offset:20736
    s_cselect_b32 s41, s41, 0
    s_waitcnt lgkmcnt(10)
    v_mfma_f32_32x32x16_bf16 v[208:223], v[236:239], v[12:15], v[208:223]
    ds_read_b64_tr_b16 v[236:237], v249 offset:21504
    ds_read_b64_tr_b16 v[238:239], v249 offset:21760
    s_waitcnt lgkmcnt(10)
    s_nop 0
    v_mfma_f32_32x32x16_bf16 v[160:175], v[240:243], v[16:19], v[160:175]
    ds_read_b64_tr_b16 v[240:241], v249 offset:22528
    ds_read_b64_tr_b16 v[242:243], v249 offset:22784
    s_waitcnt lgkmcnt(10)
    s_nop 0
    v_mfma_f32_32x32x16_bf16 v[160:175], v[244:247], v[20:23], v[160:175]
    ds_read_b64_tr_b16 v[244:245], v249 offset:23552
    ds_read_b64_tr_b16 v[246:247], v249 offset:23808
    s_add_u32 m0, s43, 16384
    s_add_u32 s45, s41, 9216
    s_add_u32 s46, s41, 18432
    s_waitcnt lgkmcnt(10)
    s_nop 0
    v_mfma_f32_32x32x16_bf16 v[160:175], v[224:227], v[24:27], v[160:175]
    ds_read_b64_tr_b16 v[224:225], v248 offset:24576
    ds_read_b64_tr_b16 v[226:227], v248 offset:24832
    s_add_u32 s47, s41, 27648
    buffer_load_dwordx4 v254, s[4:7], s41 offen offset:0 lds
    s_waitcnt lgkmcnt(10)
    s_nop 0
    v_mfma_f32_32x32x16_bf16 v[160:175], v[228:231], v[28:31], v[160:175]
    ds_read_b64_tr_b16 v[228:229], v248 offset:25600
    ds_read_b64_tr_b16 v[230:231], v248 offset:25856
    s_waitcnt lgkmcnt(10)
    s_nop 0
    v_mfma_f32_32x32x16_bf16 v[176:191], v[232:235], v[16:19], v[176:191]
    ds_read_b64_tr_b16 v[232:233], v248 offset:26624
    ds_read_b64_tr_b16 v[234:235], v248 offset:26880
    s_waitcnt lgkmcnt(10)
    s_nop 0
    v_mfma_f32_32x32x16_bf16 v[176:191], v[236:239], v[20:23], v[176:191]
    ds_read_b64_tr_b16 v[236:237], v248 offset:27648
    ds_read_b64_tr_b16 v[238:239], v248 offset:27904
    buffer_load_dwordx4 v255, s[4:7], s45 offen offset:1024 lds
    s_waitcnt lgkmcnt(10)
    s_nop 0
    v_mfma_f32_32x32x16_bf16 v[176:191], v[240:243], v[24:27], v[176:191]
    ds_read_b64_tr_b16 v[240:241], v249 offset:28672
    ds_read_b64_tr_b16 v[242:243], v249 offset:28928
    s_waitcnt vmcnt(6)
    s_nop 0
    ds_read_b128 v[32:35], v250 offset:8192
    ds_read_b128 v[36:39], v251 offset:8192
    s_waitcnt lgkmcnt(12)
    s_nop 0
    v_mfma_f32_32x32x16_bf16 v[176:191], v[244:247], v[28:31], v[176:191]
    ds_read_b64_tr_b16 v[244:245], v249 offset:29696
    ds_read_b64_tr_b16 v[246:247], v249 offset:29952
    ds_read_b128 v[40:43], v252 offset:8192
    ds_read_b128 v[44:47], v253 offset:8192
    s_waitcnt lgkmcnt(14)
    s_nop 0
    v_mfma_f32_32x32x16_bf16 v[192:207], v[224:227], v[16:19], v[192:207]
    ds_read_b64_tr_b16 v[224:225], v249 offset:30720
    ds_read_b64_tr_b16 v[226:227], v249 offset:30976
    s_waitcnt lgkmcnt(14)
    s_nop 0
    v_mfma_f32_32x32x16_bf16 v[192:207], v[228:231], v[20:23], v[192:207]
    ds_read_b64_tr_b16 v[228:229], v249 offset:31744
    ds_read_b64_tr_b16 v[230:231], v249 offset:32000
    buffer_load_dwordx4 v254, s[4:7], s46 offen offset:2048 lds
    s_waitcnt lgkmcnt(14)
    s_nop 0
    v_mfma_f32_32x32x16_bf16 v[192:207], v[232:235], v[24:27], v[192:207]
    s_barrier
    s_nop 0
    ds_read_b64_tr_b16 v[232:233], v248 offset:32768
    ds_read_b64_tr_b16 v[234:235], v248 offset:33024
    s_waitcnt lgkmcnt(14)
    s_nop 0
    v_mfma_f32_32x32x16_bf16 v[192:207], v[236:239], v[28:31], v[192:207]
    ds_read_b64_tr_b16 v[236:237], v248 offset:33792
    ds_read_b64_tr_b16 v[238:239], v248 offset:34048
    s_waitcnt lgkmcnt(14)
    s_nop 0
    v_mfma_f32_32x32x16_bf16 v[208:223], v[240:243], v[16:19], v[208:223]
    ds_read_b64_tr_b16 v[240:241], v248 offset:34816
    ds_read_b64_tr_b16 v[242:243], v248 offset:35072
    s_waitcnt lgkmcnt(12)
    s_nop 0
    v_mfma_f32_32x32x16_bf16 v[208:223], v[244:247], v[20:23], v[208:223]
    ds_read_b64_tr_b16 v[244:245], v248 offset:35840
    ds_read_b64_tr_b16 v[246:247], v248 offset:36096
    buffer_load_dwordx4 v255, s[4:7], s47 offen offset:3072 lds
    s_addk_i32 s41, 128
    s_cmpk_lg_u32 s41, 1280
    s_waitcnt lgkmcnt(10)
    s_nop 0
    v_mfma_f32_32x32x16_bf16 v[208:223], v[224:227], v[24:27], v[208:223]
    ds_read_b64_tr_b16 v[224:225], v249 offset:36864
    ds_read_b64_tr_b16 v[226:227], v249 offset:37120
    s_cselect_b32 s41, s41, 0
    s_waitcnt lgkmcnt(10)
    v_mfma_f32_32x32x16_bf16 v[208:223], v[228:231], v[28:31], v[208:223]
    ds_read_b64_tr_b16 v[228:229], v249 offset:37888
    ds_read_b64_tr_b16 v[230:231], v249 offset:38144
    s_waitcnt lgkmcnt(10)
    s_nop 0
    v_mfma_f32_32x32x16_bf16 v[160:175], v[232:235], v[32:35], v[160:175]
    ds_read_b64_tr_b16 v[232:233], v249 offset:38912
    ds_read_b64_tr_b16 v[234:235], v249 offset:39168
    s_waitcnt lgkmcnt(10)
    s_nop 0
    v_mfma_f32_32x32x16_bf16 v[160:175], v[236:239], v[36:39], v[160:175]
    ds_read_b64_tr_b16 v[236:237], v249 offset:39936
    ds_read_b64_tr_b16 v[238:239], v249 offset:40192
    s_add_u32 m0, s43, 20480
    s_add_u32 s45, s41, 9216
    s_add_u32 s46, s41, 18432
    s_waitcnt lgkmcnt(10)
    s_nop 0
    v_mfma_f32_32x32x16_bf16 v[160:175], v[240:243], v[40:43], v[160:175]
    ds_read_b64_tr_b16 v[240:241], v248 offset:40960
    ds_read_b64_tr_b16 v[242:243], v248 offset:41216
    s_add_u32 s47, s41, 27648
    buffer_load_dwordx4 v254, s[4:7], s41 offen offset:0 lds
    s_waitcnt lgkmcnt(10)
    s_nop 0
    v_mfma_f32_32x32x16_bf16 v[160:175], v[244:247], v[44:47], v[160:175]
    ds_read_b64_tr_b16 v[244:245], v248 offset:41984
    ds_read_b64_tr_b16 v[246:247], v248 offset:42240
    s_waitcnt lgkmcnt(10)
    s_nop 0
    v_mfma_f32_32x32x16_bf16 v[176:191], v[224:227], v[32:35], v[176:191]
    ds_read_b64_tr_b16 v[224:225], v248 offset:43008
    ds_read_b64_tr_b16 v[226:227], v248 offset:43264
    s_waitcnt lgkmcnt(10)
    s_nop 0
    v_mfma_f32_32x32x16_bf16 v[176:191], v[228:231], v[36:39], v[176:191]
    ds_read_b64_tr_b16 v[228:229], v248 offset:44032
    ds_read_b64_tr_b16 v[230:231], v248 offset:44288
    buffer_load_dwordx4 v255, s[4:7], s45 offen offset:1024 lds
    s_waitcnt lgkmcnt(10)
    s_nop 0
    v_mfma_f32_32x32x16_bf16 v[176:191], v[232:235], v[40:43], v[176:191]
    ds_read_b64_tr_b16 v[232:233], v249 offset:45056
    ds_read_b64_tr_b16 v[234:235], v249 offset:45312
    s_waitcnt vmcnt(6)
    s_nop 0
    ds_read_b128 v[48:51], v250 offset:12288
    ds_read_b128 v[52:55], v251 offset:12288
    s_waitcnt lgkmcnt(12)
    s_nop 0
    v_mfma_f32_32x32x16_bf16 v[176:191], v[236:239], v[44:47], v[176:191]
    ds_read_b64_tr_b16 v[236:237], v249 offset:46080
    ds_read_b64_tr_b16 v[238:239], v249 offset:46336
    ds_read_b128 v[56:59], v252 offset:12288
    ds_read_b128 v[60:63], v253 offset:12288
    s_waitcnt lgkmcnt(14)
    s_nop 0
    v_mfma_f32_32x32x16_bf16 v[192:207], v[240:243], v[32:35], v[192:207]
    ds_read_b64_tr_b16 v[240:241], v249 offset:47104
    ds_read_b64_tr_b16 v[242:243], v249 offset:47360
    s_waitcnt lgkmcnt(14)
    s_nop 0
    v_mfma_f32_32x32x16_bf16 v[192:207], v[244:247], v[36:39], v[192:207]
    ds_read_b64_tr_b16 v[244:245], v249 offset:48128
    ds_read_b64_tr_b16 v[246:247], v249 offset:48384
    buffer_load_dwordx4 v254, s[4:7], s46 offen offset:2048 lds
    s_waitcnt lgkmcnt(14)
    s_nop 0
    v_mfma_f32_32x32x16_bf16 v[192:207], v[224:227], v[40:43], v[192:207]
    s_barrier
    s_nop 0
    ds_read_b64_tr_b16 v[224:225], v248 offset:0
    ds_read_b64_tr_b16 v[226:227], v248 offset:256
    s_waitcnt lgkmcnt(14)
    s_nop 0
    v_mfma_f32_32x32x16_bf16 v[192:207], v[228:231], v[44:47], v[192:207]
    ds_read_b64_tr_b16 v[228:229], v248 offset:1024
    ds_read_b64_tr_b16 v[230:231], v248 offset:1280
    s_waitcnt lgkmcnt(14)
    s_nop 0
    v_mfma_f32_32x32x16_bf16 v[208:223], v[232:235], v[32:35], v[208:223]
    ds_read_b64_tr_b16 v[232:233], v248 offset:2048
    ds_read_b64_tr_b16 v[234:235], v248 offset:2304
    s_waitcnt lgkmcnt(12)
    s_nop 0
    v_mfma_f32_32x32x16_bf16 v[208:223], v[236:239], v[36:39], v[208:223]
    ds_read_b64_tr_b16 v[236:237], v248 offset:3072
    ds_read_b64_tr_b16 v[238:239], v248 offset:3328
    buffer_load_dwordx4 v255, s[4:7], s47 offen offset:3072 lds
    s_addk_i32 s41, 128
    s_cmpk_lg_u32 s41, 1280
    s_waitcnt lgkmcnt(10)
    s_nop 0
    v_mfma_f32_32x32x16_bf16 v[208:223], v[240:243], v[40:43], v[208:223]
    ds_read_b64_tr_b16 v[240:241], v249 offset:4096
    ds_read_b64_tr_b16 v[242:243], v249 offset:4352
    s_cselect_b32 s41, s41, 0
    s_waitcnt lgkmcnt(10)
    v_mfma_f32_32x32x16_bf16 v[208:223], v[244:247], v[44:47], v[208:223]
    ds_read_b64_tr_b16 v[244:245], v249 offset:5120
    ds_read_b64_tr_b16 v[246:247], v249 offset:5376
    s_waitcnt lgkmcnt(10)
    s_nop 0
    v_mfma_f32_32x32x16_bf16 v[160:175], v[224:227], v[48:51], v[160:175]
    ds_read_b64_tr_b16 v[224:225], v249 offset:6144
    ds_read_b64_tr_b16 v[226:227], v249 offset:6400
    s_waitcnt lgkmcnt(10)
    s_nop 0
    v_mfma_f32_32x32x16_bf16 v[160:175], v[228:231], v[52:55], v[160:175]
    ds_read_b64_tr_b16 v[228:229], v249 offset:7168
    ds_read_b64_tr_b16 v[230:231], v249 offset:7424
    s_mov_b32 m0, s43
    s_nop 0
    s_add_u32 s45, s41, 9216
    s_add_u32 s46, s41, 18432
    s_waitcnt lgkmcnt(10)
    s_nop 0
    v_mfma_f32_32x32x16_bf16 v[160:175], v[232:235], v[56:59], v[160:175]
    ds_read_b64_tr_b16 v[232:233], v248 offset:8192
    ds_read_b64_tr_b16 v[234:235], v248 offset:8448
    s_add_u32 s47, s41, 27648
    buffer_load_dwordx4 v254, s[4:7], s41 offen offset:0 lds
    s_waitcnt lgkmcnt(10)
    s_nop 0
    v_mfma_f32_32x32x16_bf16 v[160:175], v[236:239], v[60:63], v[160:175]
    ds_read_b64_tr_b16 v[236:237], v248 offset:9216
    ds_read_b64_tr_b16 v[238:239], v248 offset:9472
    s_waitcnt lgkmcnt(10)
    s_nop 0
    v_mfma_f32_32x32x16_bf16 v[176:191], v[240:243], v[48:51], v[176:191]
    ds_read_b64_tr_b16 v[240:241], v248 offset:10240
    ds_read_b64_tr_b16 v[242:243], v248 offset:10496
    s_waitcnt lgkmcnt(10)
    s_nop 0
    v_mfma_f32_32x32x16_bf16 v[176:191], v[244:247], v[52:55], v[176:191]
    ds_read_b64_tr_b16 v[244:245], v248 offset:11264
    ds_read_b64_tr_b16 v[246:247], v248 offset:11520
    buffer_load_dwordx4 v255, s[4:7], s45 offen offset:1024 lds
    s_waitcnt lgkmcnt(10)
    s_nop 0
    v_mfma_f32_32x32x16_bf16 v[176:191], v[224:227], v[56:59], v[176:191]
    ds_read_b64_tr_b16 v[224:225], v249 offset:12288
    ds_read_b64_tr_b16 v[226:227], v249 offset:12544
    s_waitcnt vmcnt(6)
    s_nop 0
    ds_read_b128 v[64:67], v250 offset:16384
    ds_read_b128 v[68:71], v251 offset:16384
    s_waitcnt lgkmcnt(12)
    s_nop 0
    v_mfma_f32_32x32x16_bf16 v[176:191], v[228:231], v[60:63], v[176:191]
    ds_read_b64_tr_b16 v[228:229], v249 offset:13312
    ds_read_b64_tr_b16 v[230:231], v249 offset:13568
    ds_read_b128 v[72:75], v252 offset:16384
    ds_read_b128 v[76:79], v253 offset:16384
    s_waitcnt lgkmcnt(14)
    s_nop 0
    v_mfma_f32_32x32x16_bf16 v[192:207], v[232:235], v[48:51], v[192:207]
    ds_read_b64_tr_b16 v[232:233], v249 offset:14336
    ds_read_b64_tr_b16 v[234:235], v249 offset:14592
    s_waitcnt lgkmcnt(14)
    s_nop 0
    v_mfma_f32_32x32x16_bf16 v[192:207], v[236:239], v[52:55], v[192:207]
    ds_read_b64_tr_b16 v[236:237], v249 offset:15360
    ds_read_b64_tr_b16 v[238:239], v249 offset:15616
    buffer_load_dwordx4 v254, s[4:7], s46 offen offset:2048 lds
    s_waitcnt lgkmcnt(14)
    s_nop 0
    v_mfma_f32_32x32x16_bf16 v[192:207], v[240:243], v[56:59], v[192:207]
    s_barrier
    s_nop 0
    ds_read_b64_tr_b16 v[240:241], v248 offset:16384
    ds_read_b64_tr_b16 v[242:243], v248 offset:16640
    s_waitcnt lgkmcnt(14)
    s_nop 0
    v_mfma_f32_32x32x16_bf16 v[192:207], v[244:247], v[60:63], v[192:207]
    ds_read_b64_tr_b16 v[244:245], v248 offset:17408
    ds_read_b64_tr_b16 v[246:247], v248 offset:17664
    s_waitcnt lgkmcnt(14)
    s_nop 0
    v_mfma_f32_32x32x16_bf16 v[208:223], v[224:227], v[48:51], v[208:223]
    ds_read_b64_tr_b16 v[224:225], v248 offset:18432
    ds_read_b64_tr_b16 v[226:227], v248 offset:18688
    s_waitcnt lgkmcnt(12)
    s_nop 0
    v_mfma_f32_32x32x16_bf16 v[208:223], v[228:231], v[52:55], v[208:223]
    ds_read_b64_tr_b16 v[228:229], v248 offset:19456
    ds_read_b64_tr_b16 v[230:231], v248 offset:19712
    buffer_load_dwordx4 v255, s[4:7], s47 offen offset:3072 lds
    s_addk_i32 s41, 128
    s_cmpk_lg_u32 s41, 1280
    s_waitcnt lgkmcnt(10)
    s_nop 0
    v_mfma_f32_32x32x16_bf16 v[208:223], v[232:235], v[56:59], v[208:223]
    ds_read_b64_tr_b16 v[232:233], v249 offset:20480
    ds_read_b64_tr_b16 v[234:235], v249 offset:20736
    s_cselect_b32 s41, s41, 0
    s_waitcnt lgkmcnt(10)
    v_mfma_f32_32x32x16_bf16 v[208:223], v[236:239], v[60:63], v[208:223]
    ds_read_b64_tr_b16 v[236:237], v249 offset:21504
    ds_read_b64_tr_b16 v[238:239], v249 offset:21760
    s_waitcnt lgkmcnt(10)
    s_nop 0
    v_mfma_f32_32x32x16_bf16 v[160:175], v[240:243], v[64:67], v[160:175]
    ds_read_b64_tr_b16 v[240:241], v249 offset:22528
    ds_read_b64_tr_b16 v[242:243], v249 offset:22784
    s_waitcnt lgkmcnt(10)
    s_nop 0
    v_mfma_f32_32x32x16_bf16 v[160:175], v[244:247], v[68:71], v[160:175]
    ds_read_b64_tr_b16 v[244:245], v249 offset:23552
    ds_read_b64_tr_b16 v[246:247], v249 offset:23808
    s_add_u32 m0, s43, 4096
    s_add_u32 s45, s41, 9216
    s_add_u32 s46, s41, 18432
    s_waitcnt lgkmcnt(10)
    s_nop 0
    v_mfma_f32_32x32x16_bf16 v[160:175], v[224:227], v[72:75], v[160:175]
    ds_read_b64_tr_b16 v[224:225], v248 offset:24576
    ds_read_b64_tr_b16 v[226:227], v248 offset:24832
    s_add_u32 s47, s41, 27648
    buffer_load_dwordx4 v254, s[4:7], s41 offen offset:0 lds
    s_waitcnt lgkmcnt(10)
    s_nop 0
    v_mfma_f32_32x32x16_bf16 v[160:175], v[228:231], v[76:79], v[160:175]
    ds_read_b64_tr_b16 v[228:229], v248 offset:25600
    ds_read_b64_tr_b16 v[230:231], v248 offset:25856
    s_waitcnt lgkmcnt(10)
    s_nop 0
    v_mfma_f32_32x32x16_bf16 v[176:191], v[232:235], v[64:67], v[176:191]
    ds_read_b64_tr_b16 v[232:233], v248 offset:26624
    ds_read_b64_tr_b16 v[234:235], v248 offset:26880
    s_waitcnt lgkmcnt(10)
    s_nop 0
    v_mfma_f32_32x32x16_bf16 v[176:191], v[236:239], v[68:71], v[176:191]
    ds_read_b64_tr_b16 v[236:237], v248 offset:27648
    ds_read_b64_tr_b16 v[238:239], v248 offset:27904
    buffer_load_dwordx4 v255, s[4:7], s45 offen offset:1024 lds
    s_waitcnt lgkmcnt(10)
    s_nop 0
    v_mfma_f32_32x32x16_bf16 v[176:191], v[240:243], v[72:75], v[176:191]
    ds_read_b64_tr_b16 v[240:241], v249 offset:28672
    ds_read_b64_tr_b16 v[242:243], v249 offset:28928
    s_waitcnt vmcnt(6)
    s_nop 0
    ds_read_b128 v[80:83], v250 offset:20480
    ds_read_b128 v[84:87], v251 offset:20480
    s_waitcnt lgkmcnt(12)
    s_nop 0
    v_mfma_f32_32x32x16_bf16 v[176:191], v[244:247], v[76:79], v[176:191]
    ds_read_b64_tr_b16 v[244:245], v249 offset:29696
    ds_read_b64_tr_b16 v[246:247], v249 offset:29952
    ds_read_b128 v[88:91], v252 offset:20480
    ds_read_b128 v[92:95], v253 offset:20480
    s_waitcnt lgkmcnt(14)
    s_nop 0
    v_mfma_f32_32x32x16_bf16 v[192:207], v[224:227], v[64:67], v[192:207]
    ds_read_b64_tr_b16 v[224:225], v249 offset:30720
    ds_read_b64_tr_b16 v[226:227], v249 offset:30976
    s_waitcnt lgkmcnt(14)
    s_nop 0
    v_mfma_f32_32x32x16_bf16 v[192:207], v[228:231], v[68:71], v[192:207]
    ds_read_b64_tr_b16 v[228:229], v249 offset:31744
    ds_read_b64_tr_b16 v[230:231], v249 offset:32000
    buffer_load_dwordx4 v254, s[4:7], s46 offen offset:2048 lds
    s_waitcnt lgkmcnt(14)
    s_nop 0
    v_mfma_f32_32x32x16_bf16 v[192:207], v[232:235], v[72:75], v[192:207]
    s_barrier
    s_nop 0
    ds_read_b64_tr_b16 v[232:233], v248 offset:32768
    ds_read_b64_tr_b16 v[234:235], v248 offset:33024
    s_waitcnt lgkmcnt(14)
    s_nop 0
    v_mfma_f32_32x32x16_bf16 v[192:207], v[236:239], v[76:79], v[192:207]
    ds_read_b64_tr_b16 v[236:237], v248 offset:33792
    ds_read_b64_tr_b16 v[238:239], v248 offset:34048
    s_waitcnt lgkmcnt(14)
    s_nop 0
    v_mfma_f32_32x32x16_bf16 v[208:223], v[240:243], v[64:67], v[208:223]
    ds_read_b64_tr_b16 v[240:241], v248 offset:34816
    ds_read_b64_tr_b16 v[242:243], v248 offset:35072
    s_waitcnt lgkmcnt(12)
    s_nop 0
    v_mfma_f32_32x32x16_bf16 v[208:223], v[244:247], v[68:71], v[208:223]
    ds_read_b64_tr_b16 v[244:245], v248 offset:35840
    ds_read_b64_tr_b16 v[246:247], v248 offset:36096
    buffer_load_dwordx4 v255, s[4:7], s47 offen offset:3072 lds
    s_addk_i32 s41, 128
    s_cmpk_lg_u32 s41, 1280
    s_waitcnt lgkmcnt(10)
    s_nop 0
    v_mfma_f32_32x32x16_bf16 v[208:223], v[224:227], v[72:75], v[208:223]
    ds_read_b64_tr_b16 v[224:225], v249 offset:36864
    ds_read_b64_tr_b16 v[226:227], v249 offset:37120
    s_cselect_b32 s41, s41, 0
    s_waitcnt lgkmcnt(10)
    v_mfma_f32_32x32x16_bf16 v[208:223], v[228:231], v[76:79], v[208:223]
    ds_read_b64_tr_b16 v[228:229], v249 offset:37888
    ds_read_b64_tr_b16 v[230:231], v249 offset:38144
    s_waitcnt lgkmcnt(10)
    s_nop 0
    v_mfma_f32_32x32x16_bf16 v[160:175], v[232:235], v[80:83], v[160:175]
    ds_read_b64_tr_b16 v[232:233], v249 offset:38912
    ds_read_b64_tr_b16 v[234:235], v249 offset:39168
    s_waitcnt lgkmcnt(10)
    s_nop 0
    v_mfma_f32_32x32x16_bf16 v[160:175], v[236:239], v[84:87], v[160:175]
    ds_read_b64_tr_b16 v[236:237], v249 offset:39936
    ds_read_b64_tr_b16 v[238:239], v249 offset:40192
    s_add_u32 m0, s43, 8192
    s_add_u32 s45, s41, 9216
    s_add_u32 s46, s41, 18432
    s_waitcnt lgkmcnt(10)
    s_nop 0
    v_mfma_f32_32x32x16_bf16 v[160:175], v[240:243], v[88:91], v[160:175]
    ds_read_b64_tr_b16 v[240:241], v248 offset:40960
    ds_read_b64_tr_b16 v[242:243], v248 offset:41216
    s_add_u32 s47, s41, 27648
    buffer_load_dwordx4 v254, s[4:7], s41 offen offset:0 lds
    s_waitcnt lgkmcnt(10)
    s_nop 0
    v_mfma_f32_32x32x16_bf16 v[160:175], v[244:247], v[92:95], v[160:175]
    ds_read_b64_tr_b16 v[244:245], v248 offset:41984
    ds_read_b64_tr_b16 v[246:247], v248 offset:42240
    s_waitcnt lgkmcnt(10)
    s_nop 0
    v_mfma_f32_32x32x16_bf16 v[176:191], v[224:227], v[80:83], v[176:191]
    ds_read_b64_tr_b16 v[224:225], v248 offset:43008
    ds_read_b64_tr_b16 v[226:227], v248 offset:43264
    s_waitcnt lgkmcnt(10)
    s_nop 0
    v_mfma_f32_32x32x16_bf16 v[176:191], v[228:231], v[84:87], v[176:191]
    ds_read_b64_tr_b16 v[228:229], v248 offset:44032
    ds_read_b64_tr_b16 v[230:231], v248 offset:44288
    buffer_load_dwordx4 v255, s[4:7], s45 offen offset:1024 lds
    s_waitcnt lgkmcnt(10)
    s_nop 0
    v_mfma_f32_32x32x16_bf16 v[176:191], v[232:235], v[88:91], v[176:191]
    ds_read_b64_tr_b16 v[232:233], v249 offset:45056
    ds_read_b64_tr_b16 v[234:235], v249 offset:45312
    s_waitcnt vmcnt(6)
    s_nop 0
    ds_read_b128 v[96:99], v250 offset:0
    ds_read_b128 v[100:103], v251 offset:0
    s_waitcnt lgkmcnt(12)
    s_nop 0
    v_mfma_f32_32x32x16_bf16 v[176:191], v[236:239], v[92:95], v[176:191]
    ds_read_b64_tr_b16 v[236:237], v249 offset:46080
    ds_read_b64_tr_b16 v[238:239], v249 offset:46336
    ds_read_b128 v[104:107], v252 offset:0
    ds_read_b128 v[108:111], v253 offset:0
    s_waitcnt lgkmcnt(14)
    s_nop 0
    v_mfma_f32_32x32x16_bf16 v[192:207], v[240:243], v[80:83], v[192:207]
    ds_read_b64_tr_b16 v[240:241], v249 offset:47104
    ds_read_b64_tr_b16 v[242:243], v249 offset:47360
    s_waitcnt lgkmcnt(14)
    s_nop 0
    v_mfma_f32_32x32x16_bf16 v[192:207], v[244:247], v[84:87], v[192:207]
    ds_read_b64_tr_b16 v[244:245], v249 offset:48128
    ds_read_b64_tr_b16 v[246:247], v249 offset:48384
    buffer_load_dwordx4 v254, s[4:7], s46 offen offset:2048 lds
    s_waitcnt lgkmcnt(14)
    s_nop 0
    v_mfma_f32_32x32x16_bf16 v[192:207], v[224:227], v[88:91], v[192:207]
    s_barrier
    s_nop 0
    ds_read_b64_tr_b16 v[224:225], v248 offset:0
    ds_read_b64_tr_b16 v[226:227], v248 offset:256
    s_waitcnt lgkmcnt(14)
    s_nop 0
    v_mfma_f32_32x32x16_bf16 v[192:207], v[228:231], v[92:95], v[192:207]
    ds_read_b64_tr_b16 v[228:229], v248 offset:1024
    ds_read_b64_tr_b16 v[230:231], v248 offset:1280
    s_waitcnt lgkmcnt(14)
    s_nop 0
    v_mfma_f32_32x32x16_bf16 v[208:223], v[232:235], v[80:83], v[208:223]
    ds_read_b64_tr_b16 v[232:233], v248 offset:2048
    ds_read_b64_tr_b16 v[234:235], v248 offset:2304
    s_waitcnt lgkmcnt(12)
    s_nop 0
    v_mfma_f32_32x32x16_bf16 v[208:223], v[236:239], v[84:87], v[208:223]
    ds_read_b64_tr_b16 v[236:237], v248 offset:3072
    ds_read_b64_tr_b16 v[238:239], v248 offset:3328
    buffer_load_dwordx4 v255, s[4:7], s47 offen offset:3072 lds
    s_addk_i32 s41, 128
    s_cmpk_lg_u32 s41, 1280
    s_waitcnt lgkmcnt(10)
    s_nop 0
    v_mfma_f32_32x32x16_bf16 v[208:223], v[240:243], v[88:91], v[208:223]
    ds_read_b64_tr_b16 v[240:241], v249 offset:4096
    ds_read_b64_tr_b16 v[242:243], v249 offset:4352
    s_cselect_b32 s41, s41, 0
    s_waitcnt lgkmcnt(10)
    v_mfma_f32_32x32x16_bf16 v[208:223], v[244:247], v[92:95], v[208:223]
    ds_read_b64_tr_b16 v[244:245], v249 offset:5120
    ds_read_b64_tr_b16 v[246:247], v249 offset:5376
    s_waitcnt lgkmcnt(10)
    s_nop 0
    v_mfma_f32_32x32x16_bf16 v[160:175], v[224:227], v[96:99], v[160:175]
    ds_read_b64_tr_b16 v[224:225], v249 offset:6144
    ds_read_b64_tr_b16 v[226:227], v249 offset:6400
    s_waitcnt lgkmcnt(10)
    s_nop 0
    v_mfma_f32_32x32x16_bf16 v[160:175], v[228:231], v[100:103], v[160:175]
    ds_read_b64_tr_b16 v[228:229], v249 offset:7168
    ds_read_b64_tr_b16 v[230:231], v249 offset:7424
    s_add_u32 m0, s43, 12288
    s_add_u32 s45, s41, 9216
    s_add_u32 s46, s41, 18432
    s_waitcnt lgkmcnt(10)
    s_nop 0
    v_mfma_f32_32x32x16_bf16 v[160:175], v[232:235], v[104:107], v[160:175]
    ds_read_b64_tr_b16 v[232:233], v248 offset:8192
    ds_read_b64_tr_b16 v[234:235], v248 offset:8448
    s_add_u32 s47, s41, 27648
    buffer_load_dwordx4 v254, s[4:7], s41 offen offset:0 lds
    s_waitcnt lgkmcnt(10)
    s_nop 0
    v_mfma_f32_32x32x16_bf16 v[160:175], v[236:239], v[108:111], v[160:175]
    ds_read_b64_tr_b16 v[236:237], v248 offset:9216
    ds_read_b64_tr_b16 v[238:239], v248 offset:9472
    s_waitcnt lgkmcnt(10)
    s_nop 0
    v_mfma_f32_32x32x16_bf16 v[176:191], v[240:243], v[96:99], v[176:191]
    ds_read_b64_tr_b16 v[240:241], v248 offset:10240
    ds_read_b64_tr_b16 v[242:243], v248 offset:10496
    s_waitcnt lgkmcnt(10)
    s_nop 0
    v_mfma_f32_32x32x16_bf16 v[176:191], v[244:247], v[100:103], v[176:191]
    ds_read_b64_tr_b16 v[244:245], v248 offset:11264
    ds_read_b64_tr_b16 v[246:247], v248 offset:11520
    buffer_load_dwordx4 v255, s[4:7], s45 offen offset:1024 lds
    s_waitcnt lgkmcnt(10)
    s_nop 0
    v_mfma_f32_32x32x16_bf16 v[176:191], v[224:227], v[104:107], v[176:191]
    ds_read_b64_tr_b16 v[224:225], v249 offset:12288
    ds_read_b64_tr_b16 v[226:227], v249 offset:12544
    s_waitcnt vmcnt(6)
    s_nop 0
    ds_read_b128 v[112:115], v250 offset:4096
    ds_read_b128 v[116:119], v251 offset:4096
    s_waitcnt lgkmcnt(12)
    s_nop 0
    v_mfma_f32_32x32x16_bf16 v[176:191], v[228:231], v[108:111], v[176:191]
    ds_read_b64_tr_b16 v[228:229], v249 offset:13312
    ds_read_b64_tr_b16 v[230:231], v249 offset:13568
    ds_read_b128 v[120:123], v252 offset:4096
    ds_read_b128 v[124:127], v253 offset:4096
    s_waitcnt lgkmcnt(14)
    s_nop 0
    v_mfma_f32_32x32x16_bf16 v[192:207], v[232:235], v[96:99], v[192:207]
    ds_read_b64_tr_b16 v[232:233], v249 offset:14336
    ds_read_b64_tr_b16 v[234:235], v249 offset:14592
    s_waitcnt lgkmcnt(14)
    s_nop 0
    v_mfma_f32_32x32x16_bf16 v[192:207], v[236:239], v[100:103], v[192:207]
    ds_read_b64_tr_b16 v[236:237], v249 offset:15360
    ds_read_b64_tr_b16 v[238:239], v249 offset:15616
    buffer_load_dwordx4 v254, s[4:7], s46 offen offset:2048 lds
    s_waitcnt lgkmcnt(14)
    s_nop 0
    v_mfma_f32_32x32x16_bf16 v[192:207], v[240:243], v[104:107], v[192:207]
    s_barrier
    s_nop 0
    ds_read_b64_tr_b16 v[240:241], v248 offset:16384
    ds_read_b64_tr_b16 v[242:243], v248 offset:16640
    s_waitcnt lgkmcnt(14)
    s_nop 0
    v_mfma_f32_32x32x16_bf16 v[192:207], v[244:247], v[108:111], v[192:207]
    ds_read_b64_tr_b16 v[244:245], v248 offset:17408
    ds_read_b64_tr_b16 v[246:247], v248 offset:17664
    s_waitcnt lgkmcnt(14)
    s_nop 0
    v_mfma_f32_32x32x16_bf16 v[208:223], v[224:227], v[96:99], v[208:223]
    ds_read_b64_tr_b16 v[224:225], v248 offset:18432
    ds_read_b64_tr_b16 v[226:227], v248 offset:18688
    s_waitcnt lgkmcnt(12)
    s_nop 0
    v_mfma_f32_32x32x16_bf16 v[208:223], v[228:231], v[100:103], v[208:223]
    ds_read_b64_tr_b16 v[228:229], v248 offset:19456
    ds_read_b64_tr_b16 v[230:231], v248 offset:19712
    buffer_load_dwordx4 v255, s[4:7], s47 offen offset:3072 lds
    s_addk_i32 s41, 128
    s_cmpk_lg_u32 s41, 1280
    s_waitcnt lgkmcnt(10)
    s_nop 0
    v_mfma_f32_32x32x16_bf16 v[208:223], v[232:235], v[104:107], v[208:223]
    ds_read_b64_tr_b16 v[232:233], v249 offset:20480
    ds_read_b64_tr_b16 v[234:235], v249 offset:20736
    s_cselect_b32 s41, s41, 0
    s_waitcnt lgkmcnt(10)
    v_mfma_f32_32x32x16_bf16 v[208:223], v[236:239], v[108:111], v[208:223]
    ds_read_b64_tr_b16 v[236:237], v249 offset:21504
    ds_read_b64_tr_b16 v[238:239], v249 offset:21760
    s_waitcnt lgkmcnt(10)
    s_nop 0
    v_mfma_f32_32x32x16_bf16 v[160:175], v[240:243], v[112:115], v[160:175]
    ds_read_b64_tr_b16 v[240:241], v249 offset:22528
    ds_read_b64_tr_b16 v[242:243], v249 offset:22784
    s_waitcnt lgkmcnt(10)
    s_nop 0
    v_mfma_f32_32x32x16_bf16 v[160:175], v[244:247], v[116:119], v[160:175]
    ds_read_b64_tr_b16 v[244:245], v249 offset:23552
    ds_read_b64_tr_b16 v[246:247], v249 offset:23808
    s_waitcnt lgkmcnt(10)
    s_nop 0
    v_mfma_f32_32x32x16_bf16 v[160:175], v[224:227], v[120:123], v[160:175]
    ds_read_b64_tr_b16 v[224:225], v248 offset:24576
    ds_read_b64_tr_b16 v[226:227], v248 offset:24832
    s_waitcnt lgkmcnt(10)
    s_nop 0
    v_mfma_f32_32x32x16_bf16 v[160:175], v[228:231], v[124:127], v[160:175]
    ds_read_b64_tr_b16 v[228:229], v248 offset:25600
    ds_read_b64_tr_b16 v[230:231], v248 offset:25856
    s_waitcnt lgkmcnt(10)
    s_nop 0
    v_mfma_f32_32x32x16_bf16 v[176:191], v[232:235], v[112:115], v[176:191]
    ds_read_b64_tr_b16 v[232:233], v248 offset:26624
    ds_read_b64_tr_b16 v[234:235], v248 offset:26880
    s_waitcnt lgkmcnt(10)
    s_nop 0
    v_mfma_f32_32x32x16_bf16 v[176:191], v[236:239], v[116:119], v[176:191]
    ds_read_b64_tr_b16 v[236:237], v248 offset:27648
    ds_read_b64_tr_b16 v[238:239], v248 offset:27904
    s_waitcnt lgkmcnt(10)
    s_nop 0
    v_mfma_f32_32x32x16_bf16 v[176:191], v[240:243], v[120:123], v[176:191]
    ds_read_b64_tr_b16 v[240:241], v249 offset:28672
    ds_read_b64_tr_b16 v[242:243], v249 offset:28928
    s_waitcnt vmcnt(4)
    s_nop 0
    ds_read_b128 v[128:131], v250 offset:8192
    ds_read_b128 v[132:135], v251 offset:8192
    s_waitcnt lgkmcnt(12)
    s_nop 0
    v_mfma_f32_32x32x16_bf16 v[176:191], v[244:247], v[124:127], v[176:191]
    ds_read_b64_tr_b16 v[244:245], v249 offset:29696
    ds_read_b64_tr_b16 v[246:247], v249 offset:29952
    ds_read_b128 v[136:139], v252 offset:8192
    ds_read_b128 v[140:143], v253 offset:8192
    s_waitcnt lgkmcnt(14)
    s_nop 0
    v_mfma_f32_32x32x16_bf16 v[192:207], v[224:227], v[112:115], v[192:207]
    ds_read_b64_tr_b16 v[224:225], v249 offset:30720
    ds_read_b64_tr_b16 v[226:227], v249 offset:30976
    s_waitcnt lgkmcnt(14)
    s_nop 0
    v_mfma_f32_32x32x16_bf16 v[192:207], v[228:231], v[116:119], v[192:207]
    ds_read_b64_tr_b16 v[228:229], v249 offset:31744
    ds_read_b64_tr_b16 v[230:231], v249 offset:32000
    s_waitcnt lgkmcnt(14)
    s_nop 0
    v_mfma_f32_32x32x16_bf16 v[192:207], v[232:235], v[120:123], v[192:207]
    s_barrier
    s_nop 0
    ds_read_b64_tr_b16 v[232:233], v248 offset:32768
    ds_read_b64_tr_b16 v[234:235], v248 offset:33024
    s_waitcnt lgkmcnt(14)
    s_nop 0
    v_mfma_f32_32x32x16_bf16 v[192:207], v[236:239], v[124:127], v[192:207]
    ds_read_b64_tr_b16 v[236:237], v248 offset:33792
    ds_read_b64_tr_b16 v[238:239], v248 offset:34048
    s_waitcnt lgkmcnt(14)
    s_nop 0
    v_mfma_f32_32x32x16_bf16 v[208:223], v[240:243], v[112:115], v[208:223]
    ds_read_b64_tr_b16 v[240:241], v248 offset:34816
    ds_read_b64_tr_b16 v[242:243], v248 offset:35072
    s_waitcnt lgkmcnt(12)
    s_nop 0
    v_mfma_f32_32x32x16_bf16 v[208:223], v[244:247], v[116:119], v[208:223]
    ds_read_b64_tr_b16 v[244:245], v248 offset:35840
    ds_read_b64_tr_b16 v[246:247], v248 offset:36096
    s_waitcnt lgkmcnt(10)
    s_nop 0
    v_mfma_f32_32x32x16_bf16 v[208:223], v[224:227], v[120:123], v[208:223]
    ds_read_b64_tr_b16 v[224:225], v249 offset:36864
    ds_read_b64_tr_b16 v[226:227], v249 offset:37120
    s_waitcnt lgkmcnt(10)
    s_nop 0
    v_mfma_f32_32x32x16_bf16 v[208:223], v[228:231], v[124:127], v[208:223]
    ds_read_b64_tr_b16 v[228:229], v249 offset:37888
    ds_read_b64_tr_b16 v[230:231], v249 offset:38144
    s_waitcnt lgkmcnt(10)
    s_nop 0
    v_mfma_f32_32x32x16_bf16 v[160:175], v[232:235], v[128:131], v[160:175]
    ds_read_b64_tr_b16 v[232:233], v249 offset:38912
    ds_read_b64_tr_b16 v[234:235], v249 offset:39168
    s_waitcnt lgkmcnt(10)
    s_nop 0
    v_mfma_f32_32x32x16_bf16 v[160:175], v[236:239], v[132:135], v[160:175]
    ds_read_b64_tr_b16 v[236:237], v249 offset:39936
    ds_read_b64_tr_b16 v[238:239], v249 offset:40192
    s_waitcnt lgkmcnt(10)
    s_nop 0
    v_mfma_f32_32x32x16_bf16 v[160:175], v[240:243], v[136:139], v[160:175]
    ds_read_b64_tr_b16 v[240:241], v248 offset:40960
    ds_read_b64_tr_b16 v[242:243], v248 offset:41216
    s_waitcnt lgkmcnt(10)
    s_nop 0
    v_mfma_f32_32x32x16_bf16 v[160:175], v[244:247], v[140:143], v[160:175]
    ds_read_b64_tr_b16 v[244:245], v248 offset:41984
    ds_read_b64_tr_b16 v[246:247], v248 offset:42240
    s_waitcnt lgkmcnt(10)
    s_nop 0
    v_mfma_f32_32x32x16_bf16 v[176:191], v[224:227], v[128:131], v[176:191]
    ds_read_b64_tr_b16 v[224:225], v248 offset:43008
    ds_read_b64_tr_b16 v[226:227], v248 offset:43264
    s_waitcnt lgkmcnt(10)
    s_nop 0
    v_mfma_f32_32x32x16_bf16 v[176:191], v[228:231], v[132:135], v[176:191]
    ds_read_b64_tr_b16 v[228:229], v248 offset:44032
    ds_read_b64_tr_b16 v[230:231], v248 offset:44288
    s_waitcnt lgkmcnt(10)
    s_nop 0
    v_mfma_f32_32x32x16_bf16 v[176:191], v[232:235], v[136:139], v[176:191]
    ds_read_b64_tr_b16 v[232:233], v249 offset:45056
    ds_read_b64_tr_b16 v[234:235], v249 offset:45312
    s_waitcnt vmcnt(0)
    s_nop 0
    ds_read_b128 v[144:147], v250 offset:12288
    ds_read_b128 v[148:151], v251 offset:12288
    s_waitcnt lgkmcnt(12)
    s_nop 0
    v_mfma_f32_32x32x16_bf16 v[176:191], v[236:239], v[140:143], v[176:191]
    ds_read_b64_tr_b16 v[236:237], v249 offset:46080
    ds_read_b64_tr_b16 v[238:239], v249 offset:46336
    ds_read_b128 v[152:155], v252 offset:12288
    ds_read_b128 v[156:159], v253 offset:12288
    s_waitcnt lgkmcnt(14)
    s_nop 0
    v_mfma_f32_32x32x16_bf16 v[192:207], v[240:243], v[128:131], v[192:207]
    ds_read_b64_tr_b16 v[240:241], v249 offset:47104
    ds_read_b64_tr_b16 v[242:243], v249 offset:47360
    s_waitcnt lgkmcnt(14)
    s_nop 0
    v_mfma_f32_32x32x16_bf16 v[192:207], v[244:247], v[132:135], v[192:207]
    ds_read_b64_tr_b16 v[244:245], v249 offset:48128
    ds_read_b64_tr_b16 v[246:247], v249 offset:48384
    s_waitcnt lgkmcnt(14)
    s_nop 0
    v_mfma_f32_32x32x16_bf16 v[192:207], v[224:227], v[136:139], v[192:207]
    s_barrier
    s_nop 0
    ds_read_b64_tr_b16 v[224:225], v248 offset:0
    ds_read_b64_tr_b16 v[226:227], v248 offset:256
    s_waitcnt lgkmcnt(14)
    s_nop 0
    v_mfma_f32_32x32x16_bf16 v[192:207], v[228:231], v[140:143], v[192:207]
    ds_read_b64_tr_b16 v[228:229], v248 offset:1024
    ds_read_b64_tr_b16 v[230:231], v248 offset:1280
    s_waitcnt lgkmcnt(14)
    s_nop 0
    v_mfma_f32_32x32x16_bf16 v[208:223], v[232:235], v[128:131], v[208:223]
    ds_read_b64_tr_b16 v[232:233], v248 offset:2048
    ds_read_b64_tr_b16 v[234:235], v248 offset:2304
    s_waitcnt lgkmcnt(12)
    s_nop 0
    v_mfma_f32_32x32x16_bf16 v[208:223], v[236:239], v[132:135], v[208:223]
    ds_read_b64_tr_b16 v[236:237], v248 offset:3072
    ds_read_b64_tr_b16 v[238:239], v248 offset:3328
    s_waitcnt lgkmcnt(10)
    s_nop 0
    v_mfma_f32_32x32x16_bf16 v[208:223], v[240:243], v[136:139], v[208:223]
    ds_read_b64_tr_b16 v[240:241], v249 offset:4096
    ds_read_b64_tr_b16 v[242:243], v249 offset:4352
    s_waitcnt lgkmcnt(10)
    s_nop 0
    v_mfma_f32_32x32x16_bf16 v[208:223], v[244:247], v[140:143], v[208:223]
    ds_read_b64_tr_b16 v[244:245], v249 offset:5120
    ds_read_b64_tr_b16 v[246:247], v249 offset:5376
    s_waitcnt lgkmcnt(10)
    s_nop 0
    v_mfma_f32_32x32x16_bf16 v[160:175], v[224:227], v[144:147], v[160:175]
    ds_read_b64_tr_b16 v[224:225], v249 offset:6144
    ds_read_b64_tr_b16 v[226:227], v249 offset:6400
    s_waitcnt lgkmcnt(10)
    s_nop 0
    v_mfma_f32_32x32x16_bf16 v[160:175], v[228:231], v[148:151], v[160:175]
    ds_read_b64_tr_b16 v[228:229], v249 offset:7168
    ds_read_b64_tr_b16 v[230:231], v249 offset:7424
    s_waitcnt lgkmcnt(10)
    s_nop 0
    v_mfma_f32_32x32x16_bf16 v[160:175], v[232:235], v[152:155], v[160:175]
    ds_read_b64_tr_b16 v[232:233], v248 offset:8192
    ds_read_b64_tr_b16 v[234:235], v248 offset:8448
    s_waitcnt lgkmcnt(10)
    s_nop 0
    v_mfma_f32_32x32x16_bf16 v[160:175], v[236:239], v[156:159], v[160:175]
    ds_read_b64_tr_b16 v[236:237], v248 offset:9216
    ds_read_b64_tr_b16 v[238:239], v248 offset:9472
    s_waitcnt lgkmcnt(10)
    s_nop 0
    v_mfma_f32_32x32x16_bf16 v[176:191], v[240:243], v[144:147], v[176:191]
    ds_read_b64_tr_b16 v[240:241], v248 offset:10240
    ds_read_b64_tr_b16 v[242:243], v248 offset:10496
    s_waitcnt lgkmcnt(10)
    s_nop 0
    v_mfma_f32_32x32x16_bf16 v[176:191], v[244:247], v[148:151], v[176:191]
    ds_read_b64_tr_b16 v[244:245], v248 offset:11264
    ds_read_b64_tr_b16 v[246:247], v248 offset:11520
    s_nop 0
    s_nop 0
    v_cvt_pk_bf16_f32 v160, v160, v161
    v_cvt_pk_bf16_f32 v161, v162, v163
    v_cvt_pk_bf16_f32 v162, v164, v165
    v_cvt_pk_bf16_f32 v163, v166, v167
    s_waitcnt lgkmcnt(10)
    s_nop 0
    v_mfma_f32_32x32x16_bf16 v[176:191], v[224:227], v[152:155], v[176:191]
    ds_read_b64_tr_b16 v[224:225], v249 offset:12288
    ds_read_b64_tr_b16 v[226:227], v249 offset:12544
    v_cvt_pk_bf16_f32 v168, v168, v169
    v_cvt_pk_bf16_f32 v169, v170, v171
    v_cvt_pk_bf16_f32 v170, v172, v173
    v_cvt_pk_bf16_f32 v171, v174, v175
    v_permlane32_swap_b32 v160, v162
    v_permlane32_swap_b32 v161, v163
    s_waitcnt lgkmcnt(10)
    s_nop 0
    v_mfma_f32_32x32x16_bf16 v[176:191], v[228:231], v[156:159], v[176:191]
    ds_read_b64_tr_b16 v[228:229], v249 offset:13312
    ds_read_b64_tr_b16 v[230:231], v249 offset:13568
    ds_write_b128 v250, v[160:163] offset:0
    v_permlane32_swap_b32 v168, v170
    v_permlane32_swap_b32 v169, v171
    ds_write_b128 v251, v[168:171] offset:0
    v_bfe_u32 v167, v248, 9, 1
    v_lshlrev_b32 v167, 4, v167
    s_waitcnt lgkmcnt(12)
    v_mfma_f32_32x32x16_bf16 v[192:207], v[232:235], v[144:147], v[192:207]
    ds_read_b64_tr_b16 v[232:233], v249 offset:14336
    ds_read_b64_tr_b16 v[234:235], v249 offset:14592
    ds_read_b128 v[160:163], v167 offset:49664
    ds_read_b128 v[168:171], v167 offset:49728
    ds_read_b128 v[172:175], v167 offset:49760
    ds_read_b128 v[164:167], v167 offset:49696
    s_waitcnt lgkmcnt(15)
    s_nop 0
    v_mfma_f32_32x32x16_bf16 v[192:207], v[236:239], v[148:151], v[192:207]
    ds_read_b64_tr_b16 v[236:237], v249 offset:15360
    ds_read_b64_tr_b16 v[238:239], v249 offset:15616
    v_cvt_pk_bf16_f32 v176, v176, v177
    v_cvt_pk_bf16_f32 v177, v178, v179
    v_cvt_pk_bf16_f32 v178, v180, v181
    v_cvt_pk_bf16_f32 v179, v182, v183
    s_waitcnt lgkmcnt(15)
    s_nop 0
    v_mfma_f32_32x32x16_bf16 v[192:207], v[240:243], v[152:155], v[192:207]
    s_barrier
    s_nop 0
    ds_read_b64_tr_b16 v[240:241], v248 offset:16384
    ds_read_b64_tr_b16 v[242:243], v249 offset:16640
    v_cvt_pk_bf16_f32 v184, v184, v185
    v_cvt_pk_bf16_f32 v185, v186, v187
    v_cvt_pk_bf16_f32 v186, v188, v189
    v_cvt_pk_bf16_f32 v187, v190, v191
    v_permlane32_swap_b32 v176, v178
    v_permlane32_swap_b32 v177, v179
    s_waitcnt lgkmcnt(15)
    s_nop 0
    v_mfma_f32_32x32x16_bf16 v[192:207], v[244:247], v[156:159], v[192:207]
    ds_read_b64_tr_b16 v[244:245], v248 offset:17408
    ds_read_b64_tr_b16 v[246:247], v249 offset:17664
    ds_write_b128 v252, v[176:179] offset:0
    v_permlane32_swap_b32 v184, v186
    v_permlane32_swap_b32 v185, v187
    ds_write_b128 v253, v[184:187] offset:0
    v_mbcnt_lo_u32_b32 v191, -1, 0
    v_mbcnt_hi_u32_b32 v191, -1, v191
    s_waitcnt lgkmcnt(15)
    s_nop 0
    v_mfma_f32_32x32x16_bf16 v[208:223], v[224:227], v[144:147], v[208:223]
    ds_read_b64_tr_b16 v[224:225], v248 offset:18432
    ds_read_b64_tr_b16 v[226:227], v249 offset:18688
    v_lshl_add_u32 v191, v191, 4, s43
    ds_read_b128 v[176:179], v191 offset:0
    ds_read_b128 v[180:183], v191 offset:1024
    ds_read_b128 v[184:187], v191 offset:2048
    ds_read_b128 v[188:191], v191 offset:3072
    v_mfma_f32_32x32x16_bf16 v[208:223], v[228:231], v[148:151], v[208:223]
    ds_read_b64_tr_b16 v[228:229], v248 offset:19456
    ds_read_b64_tr_b16 v[230:231], v249 offset:19712
    s_mov_b32 s44, s32
    s_nop 0
    s_add_u32 s45, s32, 10240
    s_add_u32 s46, s32, 20480
    s_add_u32 s47, s32, 30720
    s_waitcnt lgkmcnt(5)
    s_nop 0
    buffer_store_dwordx4 v[176:179], v254, s[12:15], s44 offen sc1
    v_mfma_f32_32x32x16_bf16 v[208:223], v[232:235], v[152:155], v[208:223]
    ds_read_b64_tr_b16 v[232:233], v248 offset:20480
    ds_read_b64_tr_b16 v[234:235], v249 offset:20736
    s_waitcnt lgkmcnt(6)
    s_nop 0
    buffer_store_dwordx4 v[180:183], v255, s[12:15], s45 offen sc1
    s_waitcnt lgkmcnt(5)
    s_nop 0
    buffer_store_dwordx4 v[184:187], v254, s[12:15], s46 offen sc1
    s_waitcnt lgkmcnt(4)
    s_nop 0
    buffer_store_dwordx4 v[188:191], v255, s[12:15], s47 offen sc1
    v_mfma_f32_32x32x16_bf16 v[208:223], v[236:239], v[156:159], v[208:223]
    ds_read_b64_tr_b16 v[236:237], v248 offset:21504
    ds_read_b64_tr_b16 v[238:239], v249 offset:21760
    v_mfma_f32_32x32x16_bf16 v[160:175], v[240:243], v[0:3], v[160:175]
    ds_read_b64_tr_b16 v[240:241], v248 offset:22528
    ds_read_b64_tr_b16 v[242:243], v249 offset:22784
    v_mfma_f32_32x32x16_bf16 v[160:175], v[244:247], v[4:7], v[160:175]
    ds_read_b64_tr_b16 v[244:245], v248 offset:23552
    ds_read_b64_tr_b16 v[246:247], v249 offset:23808
    v_cvt_pk_bf16_f32 v192, v192, v193
    v_cvt_pk_bf16_f32 v193, v194, v195
    v_cvt_pk_bf16_f32 v194, v196, v197
    v_cvt_pk_bf16_f32 v195, v198, v199
    v_mfma_f32_32x32x16_bf16 v[160:175], v[224:227], v[8:11], v[160:175]
    ds_read_b64_tr_b16 v[224:225], v248 offset:24576
    ds_read_b64_tr_b16 v[226:227], v249 offset:24832
    v_cvt_pk_bf16_f32 v200, v200, v201
    v_cvt_pk_bf16_f32 v201, v202, v203
    v_cvt_pk_bf16_f32 v202, v204, v205
    v_cvt_pk_bf16_f32 v203, v206, v207
    v_permlane32_swap_b32 v192, v194
    v_permlane32_swap_b32 v193, v195
    s_waitcnt lgkmcnt(10)
    s_nop 0
    v_mfma_f32_32x32x16_bf16 v[160:175], v[228:231], v[12:15], v[160:175]
    ds_read_b64_tr_b16 v[228:229], v248 offset:25600
    ds_read_b64_tr_b16 v[230:231], v249 offset:25856
    ds_write_b128 v250, v[192:195] offset:4096
    v_permlane32_swap_b32 v200, v202
    v_permlane32_swap_b32 v201, v203
    ds_write_b128 v251, v[200:203] offset:4096
    v_cvt_pk_bf16_f32 v208, v208, v209
    s_waitcnt lgkmcnt(12)
    s_nop 0
    v_mfma_f32_32x32x16_bf16 v[160:175], v[232:235], v[16:19], v[160:175]
    ds_read_b64_tr_b16 v[232:233], v248 offset:26624
    ds_read_b64_tr_b16 v[234:235], v249 offset:26880
    v_cvt_pk_bf16_f32 v209, v210, v211
    v_cvt_pk_bf16_f32 v210, v212, v213
    v_cvt_pk_bf16_f32 v211, v214, v215
    v_cvt_pk_bf16_f32 v216, v216, v217
    v_cvt_pk_bf16_f32 v217, v218, v219
    s_waitcnt lgkmcnt(12)
    s_nop 0
    v_mfma_f32_32x32x16_bf16 v[160:175], v[236:239], v[20:23], v[160:175]
    ds_read_b64_tr_b16 v[236:237], v248 offset:27648
    ds_read_b64_tr_b16 v[238:239], v249 offset:27904
    v_cvt_pk_bf16_f32 v218, v220, v221
    v_cvt_pk_bf16_f32 v219, v222, v223
    v_permlane32_swap_b32 v208, v210
    v_permlane32_swap_b32 v209, v211
    ds_write_b128 v252, v[208:211] offset:4096
    v_permlane32_swap_b32 v216, v218
    v_permlane32_swap_b32 v217, v219
    s_waitcnt lgkmcnt(13)
    s_nop 0
    v_mfma_f32_32x32x16_bf16 v[160:175], v[240:243], v[24:27], v[160:175]
    ds_read_b64_tr_b16 v[240:241], v248 offset:28672
    ds_read_b64_tr_b16 v[242:243], v249 offset:28928
    ds_write_b128 v253, v[216:219] offset:4096
    s_add_u32 s34, s32, 128
    v_mbcnt_lo_u32_b32 v223, -1, 0
    v_mbcnt_hi_u32_b32 v223, -1, v223
    v_lshl_add_u32 v223, v223, 4, s43
    s_waitcnt lgkmcnt(14)
    s_nop 0
    v_mfma_f32_32x32x16_bf16 v[160:175], v[244:247], v[28:31], v[160:175]
    ds_read_b64_tr_b16 v[244:245], v248 offset:29696
    ds_read_b64_tr_b16 v[246:247], v249 offset:29952
    ds_read_b128 v[208:211], v223 offset:4096
    ds_read_b128 v[212:215], v223 offset:5120
    ds_read_b128 v[216:219], v223 offset:6144
    ds_read_b128 v[220:223], v223 offset:7168
    s_mov_b32 s44, s34
    s_waitcnt lgkmcnt(15)
    v_mfma_f32_32x32x16_bf16 v[160:175], v[224:227], v[32:35], v[160:175]
    ds_read_b64_tr_b16 v[224:225], v248 offset:30720
    ds_read_b64_tr_b16 v[226:227], v249 offset:30976
    s_add_u32 s45, s34, 10240
    s_add_u32 s46, s34, 20480
    s_add_u32 s47, s34, 30720
    s_waitcnt lgkmcnt(5)
    s_nop 0
    buffer_store_dwordx4 v[208:211], v254, s[12:15], s44 offen sc1
    s_waitcnt lgkmcnt(4)
    s_nop 0
    buffer_store_dwordx4 v[212:215], v255, s[12:15], s45 offen sc1
    v_mfma_f32_32x32x16_bf16 v[160:175], v[228:231], v[36:39], v[160:175]
    ds_read_b64_tr_b16 v[228:229], v248 offset:31744
    ds_read_b64_tr_b16 v[230:231], v249 offset:32000
    s_waitcnt lgkmcnt(5)
    s_nop 0
    buffer_store_dwordx4 v[216:219], v254, s[12:15], s46 offen sc1
    s_waitcnt lgkmcnt(4)
    s_nop 0
    buffer_store_dwordx4 v[220:223], v255, s[12:15], s47 offen sc1
    v_mfma_f32_32x32x16_bf16 v[160:175], v[232:235], v[40:43], v[160:175]
    s_barrier
    s_nop 0
    ds_read_b64_tr_b16 v[232:233], v248 offset:32768
    ds_read_b64_tr_b16 v[234:235], v249 offset:33024
    v_mfma_f32_32x32x16_bf16 v[160:175], v[236:239], v[44:47], v[160:175]
    ds_read_b64_tr_b16 v[236:237], v248 offset:33792
    ds_read_b64_tr_b16 v[238:239], v249 offset:34048
    v_mfma_f32_32x32x16_bf16 v[160:175], v[240:243], v[48:51], v[160:175]
    ds_read_b64_tr_b16 v[240:241], v248 offset:34816
    ds_read_b64_tr_b16 v[242:243], v249 offset:35072
    v_mfma_f32_32x32x16_bf16 v[160:175], v[244:247], v[52:55], v[160:175]
    ds_read_b64_tr_b16 v[244:245], v248 offset:35840
    ds_read_b64_tr_b16 v[246:247], v249 offset:36096
    s_waitcnt lgkmcnt(10)
    s_nop 0
    v_mfma_f32_32x32x16_bf16 v[160:175], v[224:227], v[56:59], v[160:175]
    ds_read_b64_tr_b16 v[224:225], v248 offset:36864
    ds_read_b64_tr_b16 v[226:227], v249 offset:37120
    s_waitcnt lgkmcnt(10)
    s_nop 0
    v_mfma_f32_32x32x16_bf16 v[160:175], v[228:231], v[60:63], v[160:175]
    ds_read_b64_tr_b16 v[228:229], v248 offset:37888
    ds_read_b64_tr_b16 v[230:231], v249 offset:38144
    s_waitcnt lgkmcnt(10)
    s_nop 0
    v_mfma_f32_32x32x16_bf16 v[160:175], v[232:235], v[64:67], v[160:175]
    ds_read_b64_tr_b16 v[232:233], v248 offset:38912
    ds_read_b64_tr_b16 v[234:235], v249 offset:39168
    s_waitcnt lgkmcnt(10)
    s_nop 0
    v_mfma_f32_32x32x16_bf16 v[160:175], v[236:239], v[68:71], v[160:175]
    ds_read_b64_tr_b16 v[236:237], v248 offset:39936
    ds_read_b64_tr_b16 v[238:239], v249 offset:40192
    s_waitcnt lgkmcnt(10)
    s_nop 0
    v_mfma_f32_32x32x16_bf16 v[160:175], v[240:243], v[72:75], v[160:175]
    ds_read_b64_tr_b16 v[240:241], v248 offset:40960
    ds_read_b64_tr_b16 v[242:243], v249 offset:41216
    s_waitcnt lgkmcnt(10)
    s_nop 0
    v_mfma_f32_32x32x16_bf16 v[160:175], v[244:247], v[76:79], v[160:175]
    ds_read_b64_tr_b16 v[244:245], v248 offset:41984
    ds_read_b64_tr_b16 v[246:247], v249 offset:42240
    s_waitcnt lgkmcnt(10)
    s_nop 0
    v_mfma_f32_32x32x16_bf16 v[160:175], v[224:227], v[80:83], v[160:175]
    ds_read_b64_tr_b16 v[224:225], v248 offset:43008
    ds_read_b64_tr_b16 v[226:227], v249 offset:43264
    s_waitcnt lgkmcnt(10)
    s_nop 0
    v_mfma_f32_32x32x16_bf16 v[160:175], v[228:231], v[84:87], v[160:175]
    ds_read_b64_tr_b16 v[228:229], v248 offset:44032
    ds_read_b64_tr_b16 v[230:231], v249 offset:44288
    s_waitcnt lgkmcnt(10)
    s_nop 0
    v_mfma_f32_32x32x16_bf16 v[160:175], v[232:235], v[88:91], v[160:175]
    ds_read_b64_tr_b16 v[232:233], v248 offset:45056
    ds_read_b64_tr_b16 v[234:235], v249 offset:45312
    s_waitcnt lgkmcnt(10)
    s_nop 0
    v_mfma_f32_32x32x16_bf16 v[160:175], v[236:239], v[92:95], v[160:175]
    ds_read_b64_tr_b16 v[236:237], v248 offset:46080
    ds_read_b64_tr_b16 v[238:239], v249 offset:46336
    s_waitcnt lgkmcnt(10)
    s_nop 0
    v_mfma_f32_32x32x16_bf16 v[160:175], v[240:243], v[96:99], v[160:175]
    ds_read_b64_tr_b16 v[240:241], v248 offset:47104
    ds_read_b64_tr_b16 v[242:243], v249 offset:47360
    s_waitcnt lgkmcnt(10)
    s_nop 0
    v_mfma_f32_32x32x16_bf16 v[160:175], v[244:247], v[100:103], v[160:175]
    ds_read_b64_tr_b16 v[244:245], v248 offset:48128
    ds_read_b64_tr_b16 v[246:247], v249 offset:48384
    s_waitcnt lgkmcnt(10)
    s_nop 0
    v_mfma_f32_32x32x16_bf16 v[160:175], v[224:227], v[104:107], v[160:175]
    s_barrier
    s_nop 0
    ds_read_b64_tr_b16 v[224:225], v248 offset:0
    ds_read_b64_tr_b16 v[226:227], v249 offset:256
    s_waitcnt lgkmcnt(10)
    s_nop 0
    v_mfma_f32_32x32x16_bf16 v[160:175], v[228:231], v[108:111], v[160:175]
    ds_read_b64_tr_b16 v[228:229], v248 offset:1024
    ds_read_b64_tr_b16 v[230:231], v249 offset:1280
    s_waitcnt lgkmcnt(10)
    s_nop 0
    v_mfma_f32_32x32x16_bf16 v[160:175], v[232:235], v[112:115], v[160:175]
    ds_read_b64_tr_b16 v[232:233], v248 offset:2048
    ds_read_b64_tr_b16 v[234:235], v249 offset:2304
    s_waitcnt lgkmcnt(10)
    s_nop 0
    v_mfma_f32_32x32x16_bf16 v[160:175], v[236:239], v[116:119], v[160:175]
    ds_read_b64_tr_b16 v[236:237], v248 offset:3072
    ds_read_b64_tr_b16 v[238:239], v249 offset:3328
    s_waitcnt lgkmcnt(10)
    s_nop 0
    v_mfma_f32_32x32x16_bf16 v[160:175], v[240:243], v[120:123], v[160:175]
    ds_read_b64_tr_b16 v[240:241], v248 offset:4096
    ds_read_b64_tr_b16 v[242:243], v249 offset:4352
    s_waitcnt lgkmcnt(10)
    s_nop 0
    v_mfma_f32_32x32x16_bf16 v[160:175], v[244:247], v[124:127], v[160:175]
    ds_read_b64_tr_b16 v[244:245], v248 offset:5120
    ds_read_b64_tr_b16 v[246:247], v249 offset:5376
    s_waitcnt lgkmcnt(10)
    s_nop 0
    v_mfma_f32_32x32x16_bf16 v[160:175], v[224:227], v[128:131], v[160:175]
    ds_read_b64_tr_b16 v[224:225], v248 offset:6144
    ds_read_b64_tr_b16 v[226:227], v249 offset:6400
    s_waitcnt lgkmcnt(10)
    s_nop 0
    v_mfma_f32_32x32x16_bf16 v[160:175], v[228:231], v[132:135], v[160:175]
    ds_read_b64_tr_b16 v[228:229], v248 offset:7168
    ds_read_b64_tr_b16 v[230:231], v249 offset:7424
    s_waitcnt lgkmcnt(10)
    s_nop 0
    v_mfma_f32_32x32x16_bf16 v[160:175], v[232:235], v[136:139], v[160:175]
    s_waitcnt lgkmcnt(8)
    s_nop 0
    v_mfma_f32_32x32x16_bf16 v[160:175], v[236:239], v[140:143], v[160:175]
    s_waitcnt lgkmcnt(6)
    s_nop 0
    v_mfma_f32_32x32x16_bf16 v[160:175], v[240:243], v[144:147], v[160:175]
    s_waitcnt lgkmcnt(4)
    s_nop 0
    v_mfma_f32_32x32x16_bf16 v[160:175], v[244:247], v[148:151], v[160:175]
    s_waitcnt lgkmcnt(2)
    s_nop 0
    v_mfma_f32_32x32x16_bf16 v[160:175], v[224:227], v[152:155], v[160:175]
    s_waitcnt lgkmcnt(0)
    s_nop 0
    v_mfma_f32_32x32x16_bf16 v[160:175], v[228:231], v[156:159], v[160:175]
    s_nop 12
    s_nop 0
    v_cvt_pk_bf16_f32 v160, v160, v161
    v_cvt_pk_bf16_f32 v161, v162, v163
    v_cvt_pk_bf16_f32 v162, v164, v165
    v_cvt_pk_bf16_f32 v163, v166, v167
    v_cvt_pk_bf16_f32 v168, v168, v169
    v_cvt_pk_bf16_f32 v169, v170, v171
    v_cvt_pk_bf16_f32 v170, v172, v173
    v_cvt_pk_bf16_f32 v171, v174, v175
    v_permlane32_swap_b32 v160, v162
    v_permlane32_swap_b32 v161, v163
    ds_write_b128 v250, v[160:163] offset:8192
    v_permlane32_swap_b32 v168, v170
    v_permlane32_swap_b32 v169, v171
    ds_write_b128 v251, v[168:171] offset:8192
    v_mbcnt_lo_u32_b32 v207, -1, 0
    v_mbcnt_hi_u32_b32 v207, -1, v207
    v_lshl_add_u32 v207, v207, 4, s43
    ds_read_b128 v[192:195], v207 offset:8192
    ds_read_b128 v[196:199], v207 offset:9216
    ds_read_b128 v[200:203], v207 offset:10240
    ds_read_b128 v[204:207], v207 offset:11264
    s_mov_b32 s44, s33
    s_nop 0
    s_add_u32 s45, s33, 10240
    s_add_u32 s46, s33, 20480
    s_add_u32 s47, s33, 30720
    s_mov_b32 exec_lo, 0x0f0f0f0f
    s_mov_b32 exec_hi, 0x0f0f0f0f
    s_waitcnt lgkmcnt(3)
    s_nop 0
    buffer_store_dwordx4 v[192:195], v254, s[12:15], s44 offen sc1
    s_waitcnt lgkmcnt(1)
    s_nop 0
    buffer_store_dwordx4 v[200:203], v254, s[12:15], s46 offen sc1
    s_mov_b32 exec_lo, 0xf0f0f0f0
    s_mov_b32 exec_hi, 0xf0f0f0f0
    buffer_store_dwordx4 v[196:199], v255, s[12:15], s45 offen sc1
    s_waitcnt lgkmcnt(0)
    s_nop 0
    buffer_store_dwordx4 v[204:207], v255, s[12:15], s47 offen sc1
    s_endpgm
.p2align 6
L_prod:
    s_mov_b32 s18, 1280
    s_mov_b32 s19, 0x20000
    s_cmp_eq_u32 s38, 0
    s_cselect_b32 s34, s32, s33
    s_cselect_b32 s35, 0, 512
    v_lshlrev_b32 v11, 2, v0
    buffer_load_dword v12, v11, s[16:19], s34 offen
    v_lshrrev_b32 v2, 2, v0
    v_mul_u32_u24 v4, 5120, v2
    v_lshl_add_u32 v4, v6, 4, v4
    v_add_u32 v13, s33, v4
    v_and_b32 v5, 1, v2
    v_lshlrev_b32 v5, 6, v5
    v_lshl_add_u32 v5, v2, 8, v5
    v_lshl_add_u32 v5, v6, 4, v5
    s_lshl_b32 s45, s38, 12
    v_add_u32 v14, s45, v5
    v_xor_b32 v15, 64, v14
    s_add_u32 s41, s31, s38
    s_mul_i32 s41, s41, 81920
    s_add_u32 s41, s41, 0
    s_sub_u32 s44, s41, 819200
    s_cmp_ge_u32 s41, 819200
    s_cselect_b32 s41, s44, s41
    v_mov_b32 v176, 0x7fff7fff
    v_lshl_add_u32 v11, v0, 3, s35
    s_waitcnt vmcnt(2)
    v_and_b32 v160, v176, v144
    v_and_b32 v161, v176, v148
    v_and_b32 v162, v176, v152
    v_and_b32 v163, v176, v156
    s_add_u32 s42, s42, 163840
    s_sub_u32 s44, s42, 819200
    s_cmp_ge_u32 s42, 819200
    s_cselect_b32 s42, s44, s42
    s_nop 0
    buffer_load_dwordx4 v[16:19], v8, s[8:11], s42 offen offset:0
    v_and_b32 v168, v176, v145
    v_and_b32 v169, v176, v149
    v_and_b32 v170, v176, v153
    v_and_b32 v171, v176, v157
    v_pk_max_u16 v164, v160, v161
    v_pk_max_u16 v172, v168, v169
    v_pk_min_u16 v165, v160, v161
    v_pk_min_u16 v173, v168, v169
    v_pk_max_u16 v166, v162, v163
    v_pk_max_u16 v174, v170, v171
    buffer_load_dwordx4 v[20:23], v8, s[8:11], s42 offen offset:1280
    v_pk_min_u16 v167, v162, v163
    v_pk_min_u16 v175, v170, v171
    v_pk_max_u16 v164, v164, v167
    v_pk_max_u16 v172, v172, v175
    v_pk_max_u16 v166, v166, v165
    v_pk_max_u16 v174, v174, v173
    v_pk_min_u16 v164, v164, v166
    v_pk_min_u16 v172, v172, v174
    v_pk_sub_i16 v160, v160, v164
    v_pk_sub_i16 v168, v168, v172
    buffer_load_dwordx4 v[24:27], v8, s[8:11], s42 offen offset:2560
    v_pk_sub_i16 v161, v161, v164
    v_pk_sub_i16 v169, v169, v172
    v_pk_sub_i16 v162, v162, v164
    v_pk_sub_i16 v170, v170, v172
    v_pk_sub_i16 v163, v163, v164
    v_pk_sub_i16 v171, v171, v172
    v_pk_ashrrev_i16 v160, 15, v160 op_sel_hi:[0,1]
    v_pk_ashrrev_i16 v168, 15, v168 op_sel_hi:[0,1]
    v_pk_ashrrev_i16 v161, 15, v161 op_sel_hi:[0,1]
    v_pk_ashrrev_i16 v169, 15, v169 op_sel_hi:[0,1]
    buffer_load_dwordx4 v[28:31], v8, s[8:11], s42 offen offset:3840
    v_pk_ashrrev_i16 v162, 15, v162 op_sel_hi:[0,1]
    v_pk_ashrrev_i16 v170, 15, v170 op_sel_hi:[0,1]
    v_pk_ashrrev_i16 v163, 15, v163 op_sel_hi:[0,1]
    v_pk_ashrrev_i16 v171, 15, v171 op_sel_hi:[0,1]
    v_bitop3_b32 v144, v144, v160, v160 bitop3:0x30
    v_bitop3_b32 v145, v145, v168, v168 bitop3:0x30
    v_bitop3_b32 v148, v148, v161, v161 bitop3:0x30
    v_bitop3_b32 v149, v149, v169, v169 bitop3:0x30
    v_bitop3_b32 v152, v152, v162, v162 bitop3:0x30
    v_bitop3_b32 v153, v153, v170, v170 bitop3:0x30
    s_add_u32 s42, s42, 81920
    s_sub_u32 s44, s42, 819200
    s_cmp_ge_u32 s42, 819200
    s_cselect_b32 s42, s44, s42
    s_nop 0
    buffer_load_dwordx4 v[32:35], v8, s[8:11], s42 offen offset:0
    v_bitop3_b32 v156, v156, v163, v163 bitop3:0x30
    v_bitop3_b32 v157, v157, v171, v171 bitop3:0x30
    v_and_b32 v160, v176, v146
    v_and_b32 v161, v176, v150
    v_and_b32 v162, v176, v154
    v_and_b32 v163, v176, v158
    v_and_b32 v168, v176, v147
    v_and_b32 v169, v176, v151
    v_and_b32 v170, v176, v155
    v_and_b32 v171, v176, v159
    buffer_load_dwordx4 v[36:39], v8, s[8:11], s42 offen offset:1280
    v_pk_max_u16 v164, v160, v161
    v_pk_max_u16 v172, v168, v169
    v_pk_min_u16 v165, v160, v161
    v_pk_min_u16 v173, v168, v169
    v_pk_max_u16 v166, v162, v163
    v_pk_max_u16 v174, v170, v171
    v_pk_min_u16 v167, v162, v163
    v_pk_min_u16 v175, v170, v171
    v_pk_max_u16 v164, v164, v167
    v_pk_max_u16 v172, v172, v175
    buffer_load_dwordx4 v[40:43], v8, s[8:11], s42 offen offset:2560
    v_pk_max_u16 v166, v166, v165
    v_pk_max_u16 v174, v174, v173
    v_pk_min_u16 v164, v164, v166
    v_pk_min_u16 v172, v172, v174
    v_pk_sub_i16 v160, v160, v164
    v_pk_sub_i16 v168, v168, v172
    v_pk_sub_i16 v161, v161, v164
    v_pk_sub_i16 v169, v169, v172
    v_pk_sub_i16 v162, v162, v164
    v_pk_sub_i16 v170, v170, v172
    buffer_load_dwordx4 v[44:47], v8, s[8:11], s42 offen offset:3840
    v_pk_sub_i16 v163, v163, v164
    v_pk_sub_i16 v171, v171, v172
    v_pk_ashrrev_i16 v160, 15, v160 op_sel_hi:[0,1]
    v_pk_ashrrev_i16 v168, 15, v168 op_sel_hi:[0,1]
    v_pk_ashrrev_i16 v161, 15, v161 op_sel_hi:[0,1]
    v_pk_ashrrev_i16 v169, 15, v169 op_sel_hi:[0,1]
    v_pk_ashrrev_i16 v162, 15, v162 op_sel_hi:[0,1]
    v_pk_ashrrev_i16 v170, 15, v170 op_sel_hi:[0,1]
    v_pk_ashrrev_i16 v163, 15, v163 op_sel_hi:[0,1]
    v_pk_ashrrev_i16 v171, 15, v171 op_sel_hi:[0,1]
    v_bitop3_b32 v146, v146, v160, v160 bitop3:0x30
    v_bitop3_b32 v147, v147, v168, v168 bitop3:0x30
    v_bitop3_b32 v150, v150, v161, v161 bitop3:0x30
    v_bitop3_b32 v151, v151, v169, v169 bitop3:0x30
    v_bitop3_b32 v154, v154, v162, v162 bitop3:0x30
    v_bitop3_b32 v155, v155, v170, v170 bitop3:0x30
    v_bitop3_b32 v158, v158, v163, v163 bitop3:0x30
    v_bitop3_b32 v159, v159, v171, v171 bitop3:0x30
    ds_write_b128 v9, v[144:147] offset:0
    ds_write_b128 v10, v[148:151] offset:0
    ds_write_b128 v9, v[152:155] offset:128
    ds_write_b128 v10, v[156:159] offset:128
    s_waitcnt vmcnt(8)
    v_lshlrev_b32 v2, 16, v12
    v_and_b32 v3, 0xffff0000, v12
    ds_write_b64 v11, v[2:3] offset:49152
    s_waitcnt lgkmcnt(0)
    s_barrier
    s_waitcnt vmcnt(4)
    v_and_b32 v160, v176, v16
    v_and_b32 v161, v176, v20
    v_and_b32 v162, v176, v24
    v_and_b32 v163, v176, v28
    v_and_b32 v168, v176, v17
    v_and_b32 v169, v176, v21
    v_and_b32 v170, v176, v25
    v_and_b32_e64 v171, v176, v29
    v_pk_max_u16 v164, v160, v161
    v_pk_max_u16 v172, v168, v169
    v_pk_min_u16 v165, v160, v161
    v_pk_min_u16 v173, v168, v169
    v_pk_max_u16 v166, v162, v163
    v_pk_max_u16 v174, v170, v171
    v_pk_min_u16 v167, v162, v163
    v_pk_min_u16 v175, v170, v171
    v_pk_max_u16 v164, v164, v167
    v_pk_max_u16 v172, v172, v175
    v_pk_max_u16 v166, v166, v165
    v_pk_max_u16 v174, v174, v173
    s_add_u32 s42, s42, 81920
    s_sub_u32 s44, s42, 819200
    s_cmp_ge_u32 s42, 819200
    s_cselect_b32 s42, s44, s42
    s_nop 0
    buffer_load_dwordx4 v[48:51], v8, s[8:11], s42 offen offset:0
    v_pk_min_u16 v164, v164, v166
    v_pk_min_u16 v172, v172, v174
    v_pk_sub_i16 v160, v160, v164
    v_pk_sub_i16 v168, v168, v172
    v_pk_sub_i16 v161, v161, v164
    v_pk_sub_i16 v169, v169, v172
    v_pk_sub_i16 v162, v162, v164
    v_pk_sub_i16 v170, v170, v172
    v_pk_sub_i16 v163, v163, v164
    v_pk_sub_i16 v171, v171, v172
    v_pk_ashrrev_i16 v160, 15, v160 op_sel_hi:[0,1]
    v_pk_ashrrev_i16 v168, 15, v168 op_sel_hi:[0,1]
    v_pk_ashrrev_i16 v161, 15, v161 op_sel_hi:[0,1]
    v_pk_ashrrev_i16 v169, 15, v169 op_sel_hi:[0,1]
    v_pk_ashrrev_i16 v162, 15, v162 op_sel_hi:[0,1]
    v_pk_ashrrev_i16 v170, 15, v170 op_sel_hi:[0,1]
    v_pk_ashrrev_i16 v163, 15, v163 op_sel_hi:[0,1]
    v_pk_ashrrev_i16 v171, 15, v171 op_sel_hi:[0,1]
    v_bitop3_b32 v16, v16, v160, v160 bitop3:0x30
    v_bitop3_b32 v17, v17, v168, v168 bitop3:0x30
    v_bitop3_b32 v20, v20, v161, v161 bitop3:0x30
    v_bitop3_b32 v21, v21, v169, v169 bitop3:0x30
    buffer_load_dwordx4 v[52:55], v8, s[8:11], s42 offen offset:1280
    v_bitop3_b32 v24, v24, v162, v162 bitop3:0x30
    v_bitop3_b32 v25, v25, v170, v170 bitop3:0x30
    v_bitop3_b32 v28, v28, v163, v163 bitop3:0x30
    v_bitop3_b32 v29, v29, v171, v171 bitop3:0x30
    v_and_b32 v160, v176, v18
    v_and_b32 v161, v176, v22
    v_and_b32 v162, v176, v26
    v_and_b32 v163, v176, v30
    v_and_b32 v168, v176, v19
    v_and_b32 v169, v176, v23
    v_and_b32 v170, v176, v27
    v_and_b32 v171, v176, v31
    v_pk_max_u16 v164, v160, v161
    v_pk_max_u16 v172, v168, v169
    v_pk_min_u16 v165, v160, v161
    v_pk_min_u16 v173, v168, v169
    v_pk_max_u16 v166, v162, v163
    v_pk_max_u16 v174, v170, v171
    v_pk_min_u16 v167, v162, v163
    v_pk_min_u16 v175, v170, v171
    v_pk_max_u16 v164, v164, v167
    v_pk_max_u16 v172, v172, v175
    buffer_load_dwordx4 v[56:59], v8, s[8:11], s42 offen offset:2560
    v_pk_max_u16 v166, v166, v165
    v_pk_max_u16 v174, v174, v173
    v_pk_min_u16 v164, v164, v166
    v_pk_min_u16 v172, v172, v174
    v_pk_sub_i16 v160, v160, v164
    v_pk_sub_i16 v168, v168, v172
    v_pk_sub_i16 v161, v161, v164
    v_pk_sub_i16 v169, v169, v172
    v_pk_sub_i16 v162, v162, v164
    v_pk_sub_i16 v170, v170, v172
    v_pk_sub_i16 v163, v163, v164
    v_pk_sub_i16 v171, v171, v172
    v_pk_ashrrev_i16 v160, 15, v160 op_sel_hi:[0,1]
    v_pk_ashrrev_i16 v168, 15, v168 op_sel_hi:[0,1]
    v_pk_ashrrev_i16 v161, 15, v161 op_sel_hi:[0,1]
    v_pk_ashrrev_i16 v169, 15, v169 op_sel_hi:[0,1]
    v_pk_ashrrev_i16 v162, 15, v162 op_sel_hi:[0,1]
    v_pk_ashrrev_i16 v170, 15, v170 op_sel_hi:[0,1]
    v_pk_ashrrev_i16 v163, 15, v163 op_sel_hi:[0,1]
    v_pk_ashrrev_i16 v171, 15, v171 op_sel_hi:[0,1]
    v_bitop3_b32 v18, v18, v160, v160 bitop3:0x30
    v_bitop3_b32 v19, v19, v168, v168 bitop3:0x30
    buffer_load_dwordx4 v[60:63], v8, s[8:11], s42 offen offset:3840
    v_bitop3_b32 v22, v22, v161, v161 bitop3:0x30
    v_bitop3_b32 v23, v23, v169, v169 bitop3:0x30
    v_bitop3_b32 v26, v26, v162, v162 bitop3:0x30
    v_bitop3_b32 v27, v27, v170, v170 bitop3:0x30
    v_bitop3_b32 v30, v30, v163, v163 bitop3:0x30
    v_bitop3_b32 v31, v31, v171, v171 bitop3:0x30
    s_barrier
    s_waitcnt vmcnt(4)
    v_and_b32 v160, v176, v32
    v_and_b32 v161, v176, v36
    v_and_b32 v162, v176, v40
    v_and_b32 v163, v176, v44
    v_and_b32 v168, v176, v33
    v_and_b32 v169, v176, v37
    v_and_b32 v170, v176, v41
    v_and_b32 v171, v176, v45
    ds_write_b128 v9, v[16:19] offset:32768
    v_pk_max_u16 v164, v160, v161
    v_pk_max_u16 v172, v168, v169
    v_pk_min_u16 v165, v160, v161
    v_pk_min_u16 v173, v168, v169
    v_pk_max_u16 v166, v162, v163
    v_pk_max_u16 v174, v170, v171
    v_pk_min_u16 v167, v162, v163
    v_pk_min_u16 v175, v170, v171
    v_pk_max_u16 v164, v164, v167
    v_pk_max_u16 v172, v172, v175
    v_pk_max_u16 v166, v166, v165
    v_pk_max_u16 v174, v174, v173
    s_add_u32 s42, s42, 81920
    s_sub_u32 s44, s42, 819200
    s_cmp_ge_u32 s42, 819200
    s_cselect_b32 s42, s44, s42
    s_nop 0
    buffer_load_dwordx4 v[64:67], v8, s[8:11], s42 offen offset:0
    v_pk_min_u16 v164, v164, v166
    v_pk_min_u16 v172, v172, v174
    v_pk_sub_i16 v160, v160, v164
    v_pk_sub_i16 v168, v168, v172
    v_pk_sub_i16 v161, v161, v164
    v_pk_sub_i16 v169, v169, v172
    v_pk_sub_i16 v162, v162, v164
    v_pk_sub_i16 v170, v170, v172
    v_pk_sub_i16 v163, v163, v164
    v_pk_sub_i16 v171, v171, v172
    ds_write_b128 v10, v[20:23] offset:32768
    v_pk_ashrrev_i16 v160, 15, v160 op_sel_hi:[0,1]
    v_pk_ashrrev_i16 v168, 15, v168 op_sel_hi:[0,1]
    v_pk_ashrrev_i16 v161, 15, v161 op_sel_hi:[0,1]
    v_pk_ashrrev_i16 v169, 15, v169 op_sel_hi:[0,1]
    v_pk_ashrrev_i16 v162, 15, v162 op_sel_hi:[0,1]
    v_pk_ashrrev_i16 v170, 15, v170 op_sel_hi:[0,1]
    v_pk_ashrrev_i16 v163, 15, v163 op_sel_hi:[0,1]
    v_pk_ashrrev_i16 v171, 15, v171 op_sel_hi:[0,1]
    v_bitop3_b32 v32, v32, v160, v160 bitop3:0x30
    v_bitop3_b32 v33, v33, v168, v168 bitop3:0x30
    v_bitop3_b32 v36, v36, v161, v161 bitop3:0x30
    v_bitop3_b32 v37, v37, v169, v169 bitop3:0x30
    buffer_load_dwordx4 v[68:71], v8, s[8:11], s42 offen offset:1280
    v_bitop3_b32 v40, v40, v162, v162 bitop3:0x30
    v_bitop3_b32 v41, v41, v170, v170 bitop3:0x30
    v_bitop3_b32 v44, v44, v163, v163 bitop3:0x30
    v_bitop3_b32 v45, v45, v171, v171 bitop3:0x30
    v_and_b32 v160, v176, v34
    v_and_b32 v161, v176, v38
    v_and_b32 v162, v176, v42
    v_and_b32 v163, v176, v46
    v_and_b32 v168, v176, v35
    v_and_b32 v169, v176, v39
    ds_write_b128 v9, v[24:27] offset:32896
    v_and_b32 v170, v176, v43
    v_and_b32 v171, v176, v47
    v_pk_max_u16 v164, v160, v161
    v_pk_max_u16 v172, v168, v169
    v_pk_min_u16 v165, v160, v161
    v_pk_min_u16 v173, v168, v169
    v_pk_max_u16 v166, v162, v163
    v_pk_max_u16 v174, v170, v171
    v_pk_min_u16 v167, v162, v163
    v_pk_min_u16 v175, v170, v171
    v_pk_max_u16 v164, v164, v167
    v_pk_max_u16 v172, v172, v175
    buffer_load_dwordx4 v[72:75], v8, s[8:11], s42 offen offset:2560
    v_pk_max_u16 v166, v166, v165
    v_pk_max_u16 v174, v174, v173
    v_pk_min_u16 v164, v164, v166
    v_pk_min_u16 v172, v172, v174
    v_pk_sub_i16 v160, v160, v164
    v_pk_sub_i16 v168, v168, v172
    v_pk_sub_i16 v161, v161, v164
    v_pk_sub_i16 v169, v169, v172
    v_pk_sub_i16 v162, v162, v164
    v_pk_sub_i16 v170, v170, v172
    ds_write_b128 v10, v[28:31] offset:32896
    v_pk_sub_i16 v163, v163, v164
    v_pk_sub_i16 v171, v171, v172
    v_pk_ashrrev_i16 v160, 15, v160 op_sel_hi:[0,1]
    v_pk_ashrrev_i16 v168, 15, v168 op_sel_hi:[0,1]
    v_pk_ashrrev_i16 v161, 15, v161 op_sel_hi:[0,1]
    v_pk_ashrrev_i16 v169, 15, v169 op_sel_hi:[0,1]
    v_pk_ashrrev_i16 v162, 15, v162 op_sel_hi:[0,1]
    v_pk_ashrrev_i16 v170, 15, v170 op_sel_hi:[0,1]
    v_pk_ashrrev_i16 v163, 15, v163 op_sel_hi:[0,1]
    v_pk_ashrrev_i16 v171, 15, v171 op_sel_hi:[0,1]
    v_bitop3_b32 v34, v34, v160, v160 bitop3:0x30
    v_bitop3_b32 v35, v35, v168, v168 bitop3:0x30
    buffer_load_dwordx4 v[76:79], v8, s[8:11], s42 offen offset:3840
    v_bitop3_b32 v38, v38, v161, v161 bitop3:0x30
    v_bitop3_b32 v39, v39, v169, v169 bitop3:0x30
    v_bitop3_b32 v42, v42, v162, v162 bitop3:0x30
    v_bitop3_b32 v43, v43, v170, v170 bitop3:0x30
    v_bitop3_b32 v46, v46, v163, v163 bitop3:0x30
    v_bitop3_b32 v47, v47, v171, v171 bitop3:0x30
    s_waitcnt lgkmcnt(0)
    s_barrier
    s_waitcnt vmcnt(4)
    v_and_b32 v160, v176, v48
    v_and_b32 v161, v176, v52
    v_and_b32 v162, v176, v56
    v_and_b32 v163, v176, v60
    v_and_b32 v168, v176, v49
    v_and_b32 v169, v176, v53
    v_and_b32 v170, v176, v57
    v_and_b32_e64 v171, v176, v61
    ds_write_b128 v9, v[32:35] offset:0
    v_pk_max_u16 v164, v160, v161
    v_pk_max_u16 v172, v168, v169
    v_pk_min_u16 v165, v160, v161
    v_pk_min_u16 v173, v168, v169
    v_pk_max_u16 v166, v162, v163
    v_pk_max_u16 v174, v170, v171
    v_pk_min_u16 v167, v162, v163
    v_pk_min_u16 v175, v170, v171
    v_pk_max_u16 v164, v164, v167
    v_pk_max_u16 v172, v172, v175
    v_pk_max_u16 v166, v166, v165
    v_pk_max_u16 v174, v174, v173
    s_add_u32 s42, s42, 81920
    s_sub_u32 s44, s42, 819200
    s_cmp_ge_u32 s42, 819200
    s_cselect_b32 s42, s44, s42
    s_nop 0
    buffer_load_dwordx4 v[80:83], v8, s[8:11], s42 offen offset:0
    v_pk_min_u16 v164, v164, v166
    v_pk_min_u16 v172, v172, v174
    v_pk_sub_i16 v160, v160, v164
    v_pk_sub_i16 v168, v168, v172
    v_pk_sub_i16 v161, v161, v164
    v_pk_sub_i16 v169, v169, v172
    v_pk_sub_i16 v162, v162, v164
    v_pk_sub_i16 v170, v170, v172
    v_pk_sub_i16 v163, v163, v164
    v_pk_sub_i16 v171, v171, v172
    ds_write_b128 v10, v[36:39] offset:0
    v_pk_ashrrev_i16 v160, 15, v160 op_sel_hi:[0,1]
    v_pk_ashrrev_i16 v168, 15, v168 op_sel_hi:[0,1]
    v_pk_ashrrev_i16 v161, 15, v161 op_sel_hi:[0,1]
    v_pk_ashrrev_i16 v169, 15, v169 op_sel_hi:[0,1]
    v_pk_ashrrev_i16 v162, 15, v162 op_sel_hi:[0,1]
    v_pk_ashrrev_i16 v170, 15, v170 op_sel_hi:[0,1]
    v_pk_ashrrev_i16 v163, 15, v163 op_sel_hi:[0,1]
    v_pk_ashrrev_i16 v171, 15, v171 op_sel_hi:[0,1]
    v_bitop3_b32 v48, v48, v160, v160 bitop3:0x30
    v_bitop3_b32 v49, v49, v168, v168 bitop3:0x30
    v_bitop3_b32 v52, v52, v161, v161 bitop3:0x30
    v_bitop3_b32 v53, v53, v169, v169 bitop3:0x30
    buffer_load_dwordx4 v[84:87], v8, s[8:11], s42 offen offset:1280
    v_bitop3_b32 v56, v56, v162, v162 bitop3:0x30
    v_bitop3_b32 v57, v57, v170, v170 bitop3:0x30
    v_bitop3_b32 v60, v60, v163, v163 bitop3:0x30
    v_bitop3_b32 v61, v61, v171, v171 bitop3:0x30
    v_and_b32 v160, v176, v50
    v_and_b32 v161, v176, v54
    v_and_b32 v162, v176, v58
    v_and_b32 v163, v176, v62
    v_and_b32 v168, v176, v51
    v_and_b32 v169, v176, v55
    ds_write_b128 v9, v[40:43] offset:128
    v_and_b32 v170, v176, v59
    v_and_b32 v171, v176, v63
    v_pk_max_u16 v164, v160, v161
    v_pk_max_u16 v172, v168, v169
    v_pk_min_u16 v165, v160, v161
    v_pk_min_u16 v173, v168, v169
    v_pk_max_u16 v166, v162, v163
    v_pk_max_u16 v174, v170, v171
    v_pk_min_u16 v167, v162, v163
    v_pk_min_u16 v175, v170, v171
    v_pk_max_u16 v164, v164, v167
    v_pk_max_u16 v172, v172, v175
    buffer_load_dwordx4 v[88:91], v8, s[8:11], s42 offen offset:2560
    v_pk_max_u16 v166, v166, v165
    v_pk_max_u16 v174, v174, v173
    v_pk_min_u16 v164, v164, v166
    v_pk_min_u16 v172, v172, v174
    v_pk_sub_i16 v160, v160, v164
    v_pk_sub_i16 v168, v168, v172
    v_pk_sub_i16 v161, v161, v164
    v_pk_sub_i16 v169, v169, v172
    v_pk_sub_i16 v162, v162, v164
    v_pk_sub_i16 v170, v170, v172
    ds_write_b128 v10, v[44:47] offset:128
    v_pk_sub_i16 v163, v163, v164
    v_pk_sub_i16 v171, v171, v172
    v_pk_ashrrev_i16 v160, 15, v160 op_sel_hi:[0,1]
    v_pk_ashrrev_i16 v168, 15, v168 op_sel_hi:[0,1]
    v_pk_ashrrev_i16 v161, 15, v161 op_sel_hi:[0,1]
    v_pk_ashrrev_i16 v169, 15, v169 op_sel_hi:[0,1]
    v_pk_ashrrev_i16 v162, 15, v162 op_sel_hi:[0,1]
    v_pk_ashrrev_i16 v170, 15, v170 op_sel_hi:[0,1]
    v_pk_ashrrev_i16 v163, 15, v163 op_sel_hi:[0,1]
    v_pk_ashrrev_i16 v171, 15, v171 op_sel_hi:[0,1]
    v_bitop3_b32 v50, v50, v160, v160 bitop3:0x30
    v_bitop3_b32 v51, v51, v168, v168 bitop3:0x30
    buffer_load_dwordx4 v[92:95], v8, s[8:11], s42 offen offset:3840
    v_bitop3_b32 v54, v54, v161, v161 bitop3:0x30
    v_bitop3_b32 v55, v55, v169, v169 bitop3:0x30
    v_bitop3_b32 v58, v58, v162, v162 bitop3:0x30
    v_bitop3_b32 v59, v59, v170, v170 bitop3:0x30
    v_bitop3_b32 v62, v62, v163, v163 bitop3:0x30
    v_bitop3_b32 v63, v63, v171, v171 bitop3:0x30
    s_waitcnt lgkmcnt(0)
    s_barrier
    s_waitcnt vmcnt(4)
    v_and_b32 v160, v176, v64
    v_and_b32 v161, v176, v68
    v_and_b32 v162, v176, v72
    v_and_b32 v163, v176, v76
    v_and_b32 v168, v176, v65
    v_and_b32 v169, v176, v69
    v_and_b32 v170, v176, v73
    v_and_b32_e64 v171, v176, v77
    ds_write_b128 v9, v[48:51] offset:16384
    v_pk_max_u16 v164, v160, v161
    v_pk_max_u16 v172, v168, v169
    v_pk_min_u16 v165, v160, v161
    v_pk_min_u16 v173, v168, v169
    v_pk_max_u16 v166, v162, v163
    v_pk_max_u16 v174, v170, v171
    v_pk_min_u16 v167, v162, v163
    v_pk_min_u16 v175, v170, v171
    v_pk_max_u16 v164, v164, v167
    v_pk_max_u16 v172, v172, v175
    v_pk_max_u16 v166, v166, v165
    v_pk_max_u16 v174, v174, v173
    s_add_u32 s42, s42, 81920
    s_sub_u32 s44, s42, 819200
    s_cmp_ge_u32 s42, 819200
    s_cselect_b32 s42, s44, s42
    s_nop 0
    buffer_load_dwordx4 v[96:99], v8, s[8:11], s42 offen offset:0
    v_pk_min_u16 v164, v164, v166
    v_pk_min_u16 v172, v172, v174
    v_pk_sub_i16 v160, v160, v164
    v_pk_sub_i16 v168, v168, v172
    v_pk_sub_i16 v161, v161, v164
    v_pk_sub_i16 v169, v169, v172
    v_pk_sub_i16 v162, v162, v164
    v_pk_sub_i16 v170, v170, v172
    v_pk_sub_i16 v163, v163, v164
    v_pk_sub_i16 v171, v171, v172
    ds_write_b128 v10, v[52:55] offset:16384
    v_pk_ashrrev_i16 v160, 15, v160 op_sel_hi:[0,1]
    v_pk_ashrrev_i16 v168, 15, v168 op_sel_hi:[0,1]
    v_pk_ashrrev_i16 v161, 15, v161 op_sel_hi:[0,1]
    v_pk_ashrrev_i16 v169, 15, v169 op_sel_hi:[0,1]
    v_pk_ashrrev_i16 v162, 15, v162 op_sel_hi:[0,1]
    v_pk_ashrrev_i16 v170, 15, v170 op_sel_hi:[0,1]
    v_pk_ashrrev_i16 v163, 15, v163 op_sel_hi:[0,1]
    v_pk_ashrrev_i16 v171, 15, v171 op_sel_hi:[0,1]
    v_bitop3_b32 v64, v64, v160, v160 bitop3:0x30
    v_bitop3_b32 v65, v65, v168, v168 bitop3:0x30
    v_bitop3_b32 v68, v68, v161, v161 bitop3:0x30
    v_bitop3_b32 v69, v69, v169, v169 bitop3:0x30
    buffer_load_dwordx4 v[100:103], v8, s[8:11], s42 offen offset:1280
    v_bitop3_b32 v72, v72, v162, v162 bitop3:0x30
    v_bitop3_b32 v73, v73, v170, v170 bitop3:0x30
    v_bitop3_b32 v76, v76, v163, v163 bitop3:0x30
    v_bitop3_b32 v77, v77, v171, v171 bitop3:0x30
    v_and_b32 v160, v176, v66
    v_and_b32 v161, v176, v70
    v_and_b32 v162, v176, v74
    v_and_b32 v163, v176, v78
    v_and_b32 v168, v176, v67
    v_and_b32 v169, v176, v71
    ds_write_b128 v9, v[56:59] offset:16512
    v_and_b32 v170, v176, v75
    v_and_b32 v171, v176, v79
    v_pk_max_u16 v164, v160, v161
    v_pk_max_u16 v172, v168, v169
    v_pk_min_u16 v165, v160, v161
    v_pk_min_u16 v173, v168, v169
    v_pk_max_u16 v166, v162, v163
    v_pk_max_u16 v174, v170, v171
    v_pk_min_u16 v167, v162, v163
    v_pk_min_u16 v175, v170, v171
    v_pk_max_u16 v164, v164, v167
    v_pk_max_u16 v172, v172, v175
    buffer_load_dwordx4 v[104:107], v8, s[8:11], s42 offen offset:2560
    v_pk_max_u16 v166, v166, v165
    v_pk_max_u16 v174, v174, v173
    v_pk_min_u16 v164, v164, v166
    v_pk_min_u16 v172, v172, v174
    v_pk_sub_i16 v160, v160, v164
    v_pk_sub_i16 v168, v168, v172
    v_pk_sub_i16 v161, v161, v164
    v_pk_sub_i16 v169, v169, v172
    v_pk_sub_i16 v162, v162, v164
    v_pk_sub_i16 v170, v170, v172
    ds_write_b128 v10, v[60:63] offset:16512
    v_pk_sub_i16 v163, v163, v164
    v_pk_sub_i16 v171, v171, v172
    v_pk_ashrrev_i16 v160, 15, v160 op_sel_hi:[0,1]
    v_pk_ashrrev_i16 v168, 15, v168 op_sel_hi:[0,1]
    v_pk_ashrrev_i16 v161, 15, v161 op_sel_hi:[0,1]
    v_pk_ashrrev_i16 v169, 15, v169 op_sel_hi:[0,1]
    v_pk_ashrrev_i16 v162, 15, v162 op_sel_hi:[0,1]
    v_pk_ashrrev_i16 v170, 15, v170 op_sel_hi:[0,1]
    v_pk_ashrrev_i16 v163, 15, v163 op_sel_hi:[0,1]
    v_pk_ashrrev_i16 v171, 15, v171 op_sel_hi:[0,1]
    v_bitop3_b32 v66, v66, v160, v160 bitop3:0x30
    v_bitop3_b32 v67, v67, v168, v168 bitop3:0x30
    buffer_load_dwordx4 v[108:111], v8, s[8:11], s42 offen offset:3840
    v_bitop3_b32 v70, v70, v161, v161 bitop3:0x30
    v_bitop3_b32 v71, v71, v169, v169 bitop3:0x30
    v_bitop3_b32 v74, v74, v162, v162 bitop3:0x30
    v_bitop3_b32 v75, v75, v170, v170 bitop3:0x30
    v_bitop3_b32 v78, v78, v163, v163 bitop3:0x30
    v_bitop3_b32 v79, v79, v171, v171 bitop3:0x30
    s_waitcnt lgkmcnt(0)
    s_barrier
    s_waitcnt vmcnt(4)
    v_and_b32 v160, v176, v80
    v_and_b32 v161, v176, v84
    v_and_b32 v162, v176, v88
    v_and_b32 v163, v176, v92
    v_and_b32 v168, v176, v81
    v_and_b32 v169, v176, v85
    v_and_b32 v170, v176, v89
    v_and_b32_e64 v171, v176, v93
    ds_write_b128 v9, v[64:67] offset:32768
    v_pk_max_u16 v164, v160, v161
    v_pk_max_u16 v172, v168, v169
    v_pk_min_u16 v165, v160, v161
    v_pk_min_u16 v173, v168, v169
    v_pk_max_u16 v166, v162, v163
    v_pk_max_u16 v174, v170, v171
    v_pk_min_u16 v167, v162, v163
    v_pk_min_u16 v175, v170, v171
    v_pk_max_u16 v164, v164, v167
    v_pk_max_u16 v172, v172, v175
    v_pk_max_u16 v166, v166, v165
    v_pk_max_u16 v174, v174, v173
    s_add_u32 s42, s42, 81920
    s_sub_u32 s44, s42, 819200
    s_cmp_ge_u32 s42, 819200
    s_cselect_b32 s42, s44, s42
    s_nop 0
    buffer_load_dwordx4 v[16:19], v8, s[8:11], s42 offen offset:0
    v_pk_min_u16 v164, v164, v166
    v_pk_min_u16 v172, v172, v174
    v_pk_sub_i16 v160, v160, v164
    v_pk_sub_i16 v168, v168, v172
    v_pk_sub_i16 v161, v161, v164
    v_pk_sub_i16 v169, v169, v172
    v_pk_sub_i16 v162, v162, v164
    v_pk_sub_i16 v170, v170, v172
    v_pk_sub_i16 v163, v163, v164
    v_pk_sub_i16 v171, v171, v172
    ds_write_b128 v10, v[68:71] offset:32768
    v_pk_ashrrev_i16 v160, 15, v160 op_sel_hi:[0,1]
    v_pk_ashrrev_i16 v168, 15, v168 op_sel_hi:[0,1]
    v_pk_ashrrev_i16 v161, 15, v161 op_sel_hi:[0,1]
    v_pk_ashrrev_i16 v169, 15, v169 op_sel_hi:[0,1]
    v_pk_ashrrev_i16 v162, 15, v162 op_sel_hi:[0,1]
    v_pk_ashrrev_i16 v170, 15, v170 op_sel_hi:[0,1]
    v_pk_ashrrev_i16 v163, 15, v163 op_sel_hi:[0,1]
    v_pk_ashrrev_i16 v171, 15, v171 op_sel_hi:[0,1]
    v_bitop3_b32 v80, v80, v160, v160 bitop3:0x30
    v_bitop3_b32 v81, v81, v168, v168 bitop3:0x30
    v_bitop3_b32 v84, v84, v161, v161 bitop3:0x30
    v_bitop3_b32 v85, v85, v169, v169 bitop3:0x30
    buffer_load_dwordx4 v[20:23], v8, s[8:11], s42 offen offset:1280
    v_bitop3_b32 v88, v88, v162, v162 bitop3:0x30
    v_bitop3_b32 v89, v89, v170, v170 bitop3:0x30
    v_bitop3_b32 v92, v92, v163, v163 bitop3:0x30
    v_bitop3_b32 v93, v93, v171, v171 bitop3:0x30
    v_and_b32 v160, v176, v82
    v_and_b32 v161, v176, v86
    v_and_b32 v162, v176, v90
    v_and_b32 v163, v176, v94
    v_and_b32 v168, v176, v83
    v_and_b32 v169, v176, v87
    ds_write_b128 v9, v[72:75] offset:32896
    v_and_b32 v170, v176, v91
    v_and_b32 v171, v176, v95
    v_pk_max_u16 v164, v160, v161
    v_pk_max_u16 v172, v168, v169
    v_pk_min_u16 v165, v160, v161
    v_pk_min_u16 v173, v168, v169
    v_pk_max_u16 v166, v162, v163
    v_pk_max_u16 v174, v170, v171
    v_pk_min_u16 v167, v162, v163
    v_pk_min_u16 v175, v170, v171
    v_pk_max_u16 v164, v164, v167
    v_pk_max_u16 v172, v172, v175
    buffer_load_dwordx4 v[24:27], v8, s[8:11], s42 offen offset:2560
    v_pk_max_u16 v166, v166, v165
    v_pk_max_u16 v174, v174, v173
    v_pk_min_u16 v164, v164, v166
    v_pk_min_u16 v172, v172, v174
    v_pk_sub_i16 v160, v160, v164
    v_pk_sub_i16 v168, v168, v172
    v_pk_sub_i16 v161, v161, v164
    v_pk_sub_i16 v169, v169, v172
    v_pk_sub_i16 v162, v162, v164
    v_pk_sub_i16 v170, v170, v172
    ds_write_b128 v10, v[76:79] offset:32896
    v_pk_sub_i16 v163, v163, v164
    v_pk_sub_i16 v171, v171, v172
    v_pk_ashrrev_i16 v160, 15, v160 op_sel_hi:[0,1]
    v_pk_ashrrev_i16 v168, 15, v168 op_sel_hi:[0,1]
    v_pk_ashrrev_i16 v161, 15, v161 op_sel_hi:[0,1]
    v_pk_ashrrev_i16 v169, 15, v169 op_sel_hi:[0,1]
    v_pk_ashrrev_i16 v162, 15, v162 op_sel_hi:[0,1]
    v_pk_ashrrev_i16 v170, 15, v170 op_sel_hi:[0,1]
    v_pk_ashrrev_i16 v163, 15, v163 op_sel_hi:[0,1]
    v_pk_ashrrev_i16 v171, 15, v171 op_sel_hi:[0,1]
    v_bitop3_b32 v82, v82, v160, v160 bitop3:0x30
    v_bitop3_b32 v83, v83, v168, v168 bitop3:0x30
    buffer_load_dwordx4 v[28:31], v8, s[8:11], s42 offen offset:3840
    v_bitop3_b32 v86, v86, v161, v161 bitop3:0x30
    v_bitop3_b32 v87, v87, v169, v169 bitop3:0x30
    v_bitop3_b32 v90, v90, v162, v162 bitop3:0x30
    v_bitop3_b32 v91, v91, v170, v170 bitop3:0x30
    v_bitop3_b32 v94, v94, v163, v163 bitop3:0x30
    v_bitop3_b32 v95, v95, v171, v171 bitop3:0x30
    s_waitcnt lgkmcnt(0)
    s_barrier
    s_waitcnt vmcnt(4)
    v_and_b32 v160, v176, v96
    v_and_b32 v161, v176, v100
    v_and_b32 v162, v176, v104
    v_and_b32 v163, v176, v108
    v_and_b32 v168, v176, v97
    v_and_b32 v169, v176, v101
    v_and_b32 v170, v176, v105
    v_and_b32_e64 v171, v176, v109
    ds_write_b128 v9, v[80:83] offset:0
    v_pk_max_u16 v164, v160, v161
    v_pk_max_u16 v172, v168, v169
    v_pk_min_u16 v165, v160, v161
    v_pk_min_u16 v173, v168, v169
    v_pk_max_u16 v166, v162, v163
    v_pk_max_u16 v174, v170, v171
    v_pk_min_u16 v167, v162, v163
    v_pk_min_u16 v175, v170, v171
    v_pk_max_u16 v164, v164, v167
    v_pk_max_u16 v172, v172, v175
    v_pk_max_u16 v166, v166, v165
    v_pk_max_u16 v174, v174, v173
    s_add_u32 s42, s42, 81920
    s_sub_u32 s44, s42, 819200
    s_cmp_ge_u32 s42, 819200
    s_cselect_b32 s42, s44, s42
    s_nop 0
    buffer_load_dwordx4 v[32:35], v8, s[8:11], s42 offen offset:0
    v_pk_min_u16 v164, v164, v166
    v_pk_min_u16 v172, v172, v174
    v_pk_sub_i16 v160, v160, v164
    v_pk_sub_i16 v168, v168, v172
    v_pk_sub_i16 v161, v161, v164
    v_pk_sub_i16 v169, v169, v172
    v_pk_sub_i16 v162, v162, v164
    v_pk_sub_i16 v170, v170, v172
    v_pk_sub_i16 v163, v163, v164
    v_pk_sub_i16 v171, v171, v172
    ds_write_b128 v10, v[84:87] offset:0
    v_pk_ashrrev_i16 v160, 15, v160 op_sel_hi:[0,1]
    v_pk_ashrrev_i16 v168, 15, v168 op_sel_hi:[0,1]
    v_pk_ashrrev_i16 v161, 15, v161 op_sel_hi:[0,1]
    v_pk_ashrrev_i16 v169, 15, v169 op_sel_hi:[0,1]
    v_pk_ashrrev_i16 v162, 15, v162 op_sel_hi:[0,1]
    v_pk_ashrrev_i16 v170, 15, v170 op_sel_hi:[0,1]
    v_pk_ashrrev_i16 v163, 15, v163 op_sel_hi:[0,1]
    v_pk_ashrrev_i16 v171, 15, v171 op_sel_hi:[0,1]
    v_bitop3_b32 v96, v96, v160, v160 bitop3:0x30
    v_bitop3_b32 v97, v97, v168, v168 bitop3:0x30
    v_bitop3_b32 v100, v100, v161, v161 bitop3:0x30
    v_bitop3_b32 v101, v101, v169, v169 bitop3:0x30
    buffer_load_dwordx4 v[36:39], v8, s[8:11], s42 offen offset:1280
    v_bitop3_b32 v104, v104, v162, v162 bitop3:0x30
    v_bitop3_b32 v105, v105, v170, v170 bitop3:0x30
    v_bitop3_b32 v108, v108, v163, v163 bitop3:0x30
    v_bitop3_b32 v109, v109, v171, v171 bitop3:0x30
    v_and_b32 v160, v176, v98
    v_and_b32 v161, v176, v102
    v_and_b32 v162, v176, v106
    v_and_b32 v163, v176, v110
    v_and_b32 v168, v176, v99
    v_and_b32 v169, v176, v103
    ds_write_b128 v9, v[88:91] offset:128
    v_and_b32 v170, v176, v107
    v_and_b32 v171, v176, v111
    v_pk_max_u16 v164, v160, v161
    v_pk_max_u16 v172, v168, v169
    v_pk_min_u16 v165, v160, v161
    v_pk_min_u16 v173, v168, v169
    v_pk_max_u16 v166, v162, v163
    v_pk_max_u16 v174, v170, v171
    v_pk_min_u16 v167, v162, v163
    v_pk_min_u16 v175, v170, v171
    v_pk_max_u16 v164, v164, v167
    v_pk_max_u16 v172, v172, v175
    buffer_load_dwordx4 v[40:43], v8, s[8:11], s42 offen offset:2560
    v_pk_max_u16 v166, v166, v165
    v_pk_max_u16 v174, v174, v173
    v_pk_min_u16 v164, v164, v166
    v_pk_min_u16 v172, v172, v174
    v_pk_sub_i16 v160, v160, v164
    v_pk_sub_i16 v168, v168, v172
    v_pk_sub_i16 v161, v161, v164
    v_pk_sub_i16 v169, v169, v172
    v_pk_sub_i16 v162, v162, v164
    v_pk_sub_i16 v170, v170, v172
    ds_write_b128 v10, v[92:95] offset:128
    v_pk_sub_i16 v163, v163, v164
    v_pk_sub_i16 v171, v171, v172
    v_pk_ashrrev_i16 v160, 15, v160 op_sel_hi:[0,1]
    v_pk_ashrrev_i16 v168, 15, v168 op_sel_hi:[0,1]
    v_pk_ashrrev_i16 v161, 15, v161 op_sel_hi:[0,1]
    v_pk_ashrrev_i16 v169, 15, v169 op_sel_hi:[0,1]
    v_pk_ashrrev_i16 v162, 15, v162 op_sel_hi:[0,1]
    v_pk_ashrrev_i16 v170, 15, v170 op_sel_hi:[0,1]
    v_pk_ashrrev_i16 v163, 15, v163 op_sel_hi:[0,1]
    v_pk_ashrrev_i16 v171, 15, v171 op_sel_hi:[0,1]
    v_bitop3_b32 v98, v98, v160, v160 bitop3:0x30
    v_bitop3_b32 v99, v99, v168, v168 bitop3:0x30
    buffer_load_dwordx4 v[44:47], v8, s[8:11], s42 offen offset:3840
    v_bitop3_b32 v102, v102, v161, v161 bitop3:0x30
    v_bitop3_b32 v103, v103, v169, v169 bitop3:0x30
    v_bitop3_b32 v106, v106, v162, v162 bitop3:0x30
    v_bitop3_b32 v107, v107, v170, v170 bitop3:0x30
    v_bitop3_b32 v110, v110, v163, v163 bitop3:0x30
    v_bitop3_b32 v111, v111, v171, v171 bitop3:0x30
    s_waitcnt lgkmcnt(0)
    s_barrier
    s_waitcnt vmcnt(4)
    v_and_b32 v160, v176, v16
    v_and_b32 v161, v176, v20
    v_and_b32 v162, v176, v24
    v_and_b32 v163, v176, v28
    v_and_b32 v168, v176, v17
    v_and_b32 v169, v176, v21
    v_and_b32 v170, v176, v25
    v_and_b32_e64 v171, v176, v29
    ds_write_b128 v9, v[96:99] offset:16384
    v_pk_max_u16 v164, v160, v161
    v_pk_max_u16 v172, v168, v169
    v_pk_min_u16 v165, v160, v161
    v_pk_min_u16 v173, v168, v169
    v_pk_max_u16 v166, v162, v163
    v_pk_max_u16 v174, v170, v171
    v_pk_min_u16 v167, v162, v163
    v_pk_min_u16 v175, v170, v171
    v_pk_max_u16 v164, v164, v167
    v_pk_max_u16 v172, v172, v175
    v_pk_max_u16 v166, v166, v165
    v_pk_max_u16 v174, v174, v173
    buffer_load_dwordx4 v[48:51], v13, s[8:11], s41 offen offset:0
    v_pk_min_u16 v164, v164, v166
    v_pk_min_u16 v172, v172, v174
    v_pk_sub_i16 v160, v160, v164
    v_pk_sub_i16 v168, v168, v172
    v_pk_sub_i16 v161, v161, v164
    v_pk_sub_i16 v169, v169, v172
    v_pk_sub_i16 v162, v162, v164
    v_pk_sub_i16 v170, v170, v172
    v_pk_sub_i16 v163, v163, v164
    v_pk_sub_i16 v171, v171, v172
    ds_write_b128 v10, v[100:103] offset:16384
    v_pk_ashrrev_i16 v160, 15, v160 op_sel_hi:[0,1]
    v_pk_ashrrev_i16 v168, 15, v168 op_sel_hi:[0,1]
    v_pk_ashrrev_i16 v161, 15, v161 op_sel_hi:[0,1]
    v_pk_ashrrev_i16 v169, 15, v169 op_sel_hi:[0,1]
    v_pk_ashrrev_i16 v162, 15, v162 op_sel_hi:[0,1]
    v_pk_ashrrev_i16 v170, 15, v170 op_sel_hi:[0,1]
    v_pk_ashrrev_i16 v163, 15, v163 op_sel_hi:[0,1]
    v_pk_ashrrev_i16 v171, 15, v171 op_sel_hi:[0,1]
    v_bitop3_b32 v16, v16, v160, v160 bitop3:0x30
    v_bitop3_b32 v17, v17, v168, v168 bitop3:0x30
    v_bitop3_b32 v20, v20, v161, v161 bitop3:0x30
    v_bitop3_b32 v21, v21, v169, v169 bitop3:0x30
    buffer_load_dwordx4 v[52:55], v13, s[8:11], s41 offen offset:1280
    v_bitop3_b32 v24, v24, v162, v162 bitop3:0x30
    v_bitop3_b32 v25, v25, v170, v170 bitop3:0x30
    v_bitop3_b32 v28, v28, v163, v163 bitop3:0x30
    v_bitop3_b32 v29, v29, v171, v171 bitop3:0x30
    v_and_b32 v160, v176, v18
    v_and_b32 v161, v176, v22
    v_and_b32 v162, v176, v26
    v_and_b32 v163, v176, v30
    v_and_b32 v168, v176, v19
    v_and_b32 v169, v176, v23
    ds_write_b128 v9, v[104:107] offset:16512
    v_and_b32 v170, v176, v27
    v_and_b32 v171, v176, v31
    v_pk_max_u16 v164, v160, v161
    v_pk_max_u16 v172, v168, v169
    v_pk_min_u16 v165, v160, v161
    v_pk_min_u16 v173, v168, v169
    v_pk_max_u16 v166, v162, v163
    v_pk_max_u16 v174, v170, v171
    v_pk_min_u16 v167, v162, v163
    v_pk_min_u16 v175, v170, v171
    v_pk_max_u16 v164, v164, v167
    v_pk_max_u16 v172, v172, v175
    buffer_load_dwordx4 v[56:59], v13, s[8:11], s41 offen offset:2560
    v_pk_max_u16 v166, v166, v165
    v_pk_max_u16 v174, v174, v173
    v_pk_min_u16 v164, v164, v166
    v_pk_min_u16 v172, v172, v174
    v_pk_sub_i16 v160, v160, v164
    v_pk_sub_i16 v168, v168, v172
    v_pk_sub_i16 v161, v161, v164
    v_pk_sub_i16 v169, v169, v172
    v_pk_sub_i16 v162, v162, v164
    v_pk_sub_i16 v170, v170, v172
    ds_write_b128 v10, v[108:111] offset:16512
    v_pk_sub_i16 v163, v163, v164
    v_pk_sub_i16 v171, v171, v172
    v_pk_ashrrev_i16 v160, 15, v160 op_sel_hi:[0,1]
    v_pk_ashrrev_i16 v168, 15, v168 op_sel_hi:[0,1]
    v_pk_ashrrev_i16 v161, 15, v161 op_sel_hi:[0,1]
    v_pk_ashrrev_i16 v169, 15, v169 op_sel_hi:[0,1]
    v_pk_ashrrev_i16 v162, 15, v162 op_sel_hi:[0,1]
    v_pk_ashrrev_i16 v170, 15, v170 op_sel_hi:[0,1]
    v_pk_ashrrev_i16 v163, 15, v163 op_sel_hi:[0,1]
    v_pk_ashrrev_i16 v171, 15, v171 op_sel_hi:[0,1]
    v_bitop3_b32 v18, v18, v160, v160 bitop3:0x30
    v_bitop3_b32 v19, v19, v168, v168 bitop3:0x30
    buffer_load_dwordx4 v[60:63], v13, s[8:11], s41 offen offset:3840
    v_bitop3_b32 v22, v22, v161, v161 bitop3:0x30
    v_bitop3_b32 v23, v23, v169, v169 bitop3:0x30
    v_bitop3_b32 v26, v26, v162, v162 bitop3:0x30
    v_bitop3_b32 v27, v27, v170, v170 bitop3:0x30
    v_bitop3_b32 v30, v30, v163, v163 bitop3:0x30
    v_bitop3_b32 v31, v31, v171, v171 bitop3:0x30
    s_waitcnt lgkmcnt(0)
    s_barrier
    s_waitcnt vmcnt(4)
    v_and_b32 v160, v176, v32
    v_and_b32 v161, v176, v36
    v_and_b32 v162, v176, v40
    v_and_b32 v163, v176, v44
    v_and_b32 v168, v176, v33
    v_and_b32 v169, v176, v37
    v_and_b32 v170, v176, v41
    v_and_b32_e64 v171, v176, v45
    ds_write_b128 v9, v[16:19] offset:32768
    v_pk_max_u16 v164, v160, v161
    v_pk_max_u16 v172, v168, v169
    v_pk_min_u16 v165, v160, v161
    v_pk_min_u16 v173, v168, v169
    v_pk_max_u16 v166, v162, v163
    v_pk_max_u16 v174, v170, v171
    v_pk_min_u16 v167, v162, v163
    v_pk_min_u16 v175, v170, v171
    v_pk_max_u16 v164, v164, v167
    v_pk_max_u16 v172, v172, v175
    v_pk_max_u16 v166, v166, v165
    v_pk_max_u16 v174, v174, v173
    s_add_u32 s41, s41, 327680
    s_sub_u32 s44, s41, 819200
    s_cmp_ge_u32 s41, 819200
    s_cselect_b32 s41, s44, s41
    s_nop 0
    buffer_load_dwordx4 v[64:67], v13, s[8:11], s41 offen offset:0
    v_pk_min_u16 v164, v164, v166
    v_pk_min_u16 v172, v172, v174
    v_pk_sub_i16 v160, v160, v164
    v_pk_sub_i16 v168, v168, v172
    v_pk_sub_i16 v161, v161, v164
    v_pk_sub_i16 v169, v169, v172
    v_pk_sub_i16 v162, v162, v164
    v_pk_sub_i16 v170, v170, v172
    v_pk_sub_i16 v163, v163, v164
    v_pk_sub_i16 v171, v171, v172
    ds_write_b128 v10, v[20:23] offset:32768
    v_pk_ashrrev_i16 v160, 15, v160 op_sel_hi:[0,1]
    v_pk_ashrrev_i16 v168, 15, v168 op_sel_hi:[0,1]
    v_pk_ashrrev_i16 v161, 15, v161 op_sel_hi:[0,1]
    v_pk_ashrrev_i16 v169, 15, v169 op_sel_hi:[0,1]
    v_pk_ashrrev_i16 v162, 15, v162 op_sel_hi:[0,1]
    v_pk_ashrrev_i16 v170, 15, v170 op_sel_hi:[0,1]
    v_pk_ashrrev_i16 v163, 15, v163 op_sel_hi:[0,1]
    v_pk_ashrrev_i16 v171, 15, v171 op_sel_hi:[0,1]
    v_bitop3_b32 v32, v32, v160, v160 bitop3:0x30
    v_bitop3_b32 v33, v33, v168, v168 bitop3:0x30
    v_bitop3_b32 v36, v36, v161, v161 bitop3:0x30
    v_bitop3_b32 v37, v37, v169, v169 bitop3:0x30
    buffer_load_dwordx4 v[68:71], v13, s[8:11], s41 offen offset:1280
    v_bitop3_b32 v40, v40, v162, v162 bitop3:0x30
    v_bitop3_b32 v41, v41, v170, v170 bitop3:0x30
    v_bitop3_b32 v44, v44, v163, v163 bitop3:0x30
    v_bitop3_b32 v45, v45, v171, v171 bitop3:0x30
    v_and_b32 v160, v176, v34
    v_and_b32 v161, v176, v38
    v_and_b32 v162, v176, v42
    v_and_b32 v163, v176, v46
    v_and_b32 v168, v176, v35
    v_and_b32 v169, v176, v39
    ds_write_b128 v9, v[24:27] offset:32896
    v_and_b32 v170, v176, v43
    v_and_b32 v171, v176, v47
    v_pk_max_u16 v164, v160, v161
    v_pk_max_u16 v172, v168, v169
    v_pk_min_u16 v165, v160, v161
    v_pk_min_u16 v173, v168, v169
    v_pk_max_u16 v166, v162, v163
    v_pk_max_u16 v174, v170, v171
    v_pk_min_u16 v167, v162, v163
    v_pk_min_u16 v175, v170, v171
    v_pk_max_u16 v164, v164, v167
    v_pk_max_u16 v172, v172, v175
    buffer_load_dwordx4 v[72:75], v13, s[8:11], s41 offen offset:2560
    v_pk_max_u16 v166, v166, v165
    v_pk_max_u16 v174, v174, v173
    v_pk_min_u16 v164, v164, v166
    v_pk_min_u16 v172, v172, v174
    v_pk_sub_i16 v160, v160, v164
    v_pk_sub_i16 v168, v168, v172
    v_pk_sub_i16 v161, v161, v164
    v_pk_sub_i16 v169, v169, v172
    v_pk_sub_i16 v162, v162, v164
    v_pk_sub_i16 v170, v170, v172
    ds_write_b128 v10, v[28:31] offset:32896
    v_pk_sub_i16 v163, v163, v164
    v_pk_sub_i16 v171, v171, v172
    v_pk_ashrrev_i16 v160, 15, v160 op_sel_hi:[0,1]
    v_pk_ashrrev_i16 v168, 15, v168 op_sel_hi:[0,1]
    v_pk_ashrrev_i16 v161, 15, v161 op_sel_hi:[0,1]
    v_pk_ashrrev_i16 v169, 15, v169 op_sel_hi:[0,1]
    v_pk_ashrrev_i16 v162, 15, v162 op_sel_hi:[0,1]
    v_pk_ashrrev_i16 v170, 15, v170 op_sel_hi:[0,1]
    v_pk_ashrrev_i16 v163, 15, v163 op_sel_hi:[0,1]
    v_pk_ashrrev_i16 v171, 15, v171 op_sel_hi:[0,1]
    v_bitop3_b32 v34, v34, v160, v160 bitop3:0x30
    v_bitop3_b32 v35, v35, v168, v168 bitop3:0x30
    buffer_load_dwordx4 v[76:79], v13, s[8:11], s41 offen offset:3840
    v_bitop3_b32 v38, v38, v161, v161 bitop3:0x30
    v_bitop3_b32 v39, v39, v169, v169 bitop3:0x30
    v_bitop3_b32 v42, v42, v162, v162 bitop3:0x30
    v_bitop3_b32 v43, v43, v170, v170 bitop3:0x30
    v_bitop3_b32 v46, v46, v163, v163 bitop3:0x30
    v_bitop3_b32 v47, v47, v171, v171 bitop3:0x30
    s_waitcnt lgkmcnt(0)
    s_barrier
    s_waitcnt vmcnt(4)
    v_and_b32 v160, v176, v48
    v_and_b32 v161, v176, v52
    v_and_b32 v162, v176, v56
    v_and_b32 v163, v176, v60
    v_and_b32 v168, v176, v49
    v_and_b32 v169, v176, v53
    v_and_b32 v170, v176, v57
    v_and_b32_e64 v171, v176, v61
    ds_write_b128 v9, v[32:35] offset:0
    v_pk_max_u16 v164, v160, v161
    v_pk_max_u16 v172, v168, v169
    v_pk_min_u16 v165, v160, v161
    v_pk_min_u16 v173, v168, v169
    v_pk_max_u16 v166, v162, v163
    v_pk_max_u16 v174, v170, v171
    v_pk_min_u16 v167, v162, v163
    v_pk_min_u16 v175, v170, v171
    v_pk_max_u16 v164, v164, v167
    v_pk_max_u16 v172, v172, v175
    v_pk_max_u16 v166, v166, v165
    v_pk_max_u16 v174, v174, v173
    s_add_u32 s41, s41, 327680
    s_sub_u32 s44, s41, 819200
    s_cmp_ge_u32 s41, 819200
    s_cselect_b32 s41, s44, s41
    s_nop 0
    buffer_load_dwordx4 v[80:83], v13, s[8:11], s41 offen offset:0
    v_pk_min_u16 v164, v164, v166
    v_pk_min_u16 v172, v172, v174
    v_pk_sub_i16 v160, v160, v164
    v_pk_sub_i16 v168, v168, v172
    v_pk_sub_i16 v161, v161, v164
    v_pk_sub_i16 v169, v169, v172
    v_pk_sub_i16 v162, v162, v164
    v_pk_sub_i16 v170, v170, v172
    v_pk_sub_i16 v163, v163, v164
    v_pk_sub_i16 v171, v171, v172
    ds_write_b128 v10, v[36:39] offset:0
    v_pk_ashrrev_i16 v160, 15, v160 op_sel_hi:[0,1]
    v_pk_ashrrev_i16 v168, 15, v168 op_sel_hi:[0,1]
    v_pk_ashrrev_i16 v161, 15, v161 op_sel_hi:[0,1]
    v_pk_ashrrev_i16 v169, 15, v169 op_sel_hi:[0,1]
    v_pk_ashrrev_i16 v162, 15, v162 op_sel_hi:[0,1]
    v_pk_ashrrev_i16 v170, 15, v170 op_sel_hi:[0,1]
    v_pk_ashrrev_i16 v163, 15, v163 op_sel_hi:[0,1]
    v_pk_ashrrev_i16 v171, 15, v171 op_sel_hi:[0,1]
    v_bitop3_b32 v48, v48, v160, v160 bitop3:0x30
    v_bitop3_b32 v49, v49, v168, v168 bitop3:0x30
    v_bitop3_b32 v52, v52, v161, v161 bitop3:0x30
    v_bitop3_b32 v53, v53, v169, v169 bitop3:0x30
    buffer_load_dwordx4 v[84:87], v13, s[8:11], s41 offen offset:1280
    v_bitop3_b32 v56, v56, v162, v162 bitop3:0x30
    v_bitop3_b32 v57, v57, v170, v170 bitop3:0x30
    v_bitop3_b32 v60, v60, v163, v163 bitop3:0x30
    v_bitop3_b32 v61, v61, v171, v171 bitop3:0x30
    v_and_b32 v160, v176, v50
    v_and_b32 v161, v176, v54
    v_and_b32 v162, v176, v58
    v_and_b32 v163, v176, v62
    v_and_b32 v168, v176, v51
    v_and_b32 v169, v176, v55
    ds_write_b128 v9, v[40:43] offset:128
    v_and_b32 v170, v176, v59
    v_and_b32 v171, v176, v63
    v_pk_max_u16 v164, v160, v161
    v_pk_max_u16 v172, v168, v169
    v_pk_min_u16 v165, v160, v161
    v_pk_min_u16 v173, v168, v169
    v_pk_max_u16 v166, v162, v163
    v_pk_max_u16 v174, v170, v171
    v_pk_min_u16 v167, v162, v163
    v_pk_min_u16 v175, v170, v171
    v_pk_max_u16 v164, v164, v167
    v_pk_max_u16 v172, v172, v175
    buffer_load_dwordx4 v[88:91], v13, s[8:11], s41 offen offset:2560
    v_pk_max_u16 v166, v166, v165
    v_pk_max_u16 v174, v174, v173
    v_pk_min_u16 v164, v164, v166
    v_pk_min_u16 v172, v172, v174
    v_pk_sub_i16 v160, v160, v164
    v_pk_sub_i16 v168, v168, v172
    v_pk_sub_i16 v161, v161, v164
    v_pk_sub_i16 v169, v169, v172
    v_pk_sub_i16 v162, v162, v164
    v_pk_sub_i16 v170, v170, v172
    ds_write_b128 v10, v[44:47] offset:128
    v_pk_sub_i16 v163, v163, v164
    v_pk_sub_i16 v171, v171, v172
    v_pk_ashrrev_i16 v160, 15, v160 op_sel_hi:[0,1]
    v_pk_ashrrev_i16 v168, 15, v168 op_sel_hi:[0,1]
    v_pk_ashrrev_i16 v161, 15, v161 op_sel_hi:[0,1]
    v_pk_ashrrev_i16 v169, 15, v169 op_sel_hi:[0,1]
    v_pk_ashrrev_i16 v162, 15, v162 op_sel_hi:[0,1]
    v_pk_ashrrev_i16 v170, 15, v170 op_sel_hi:[0,1]
    v_pk_ashrrev_i16 v163, 15, v163 op_sel_hi:[0,1]
    v_pk_ashrrev_i16 v171, 15, v171 op_sel_hi:[0,1]
    v_bitop3_b32 v50, v50, v160, v160 bitop3:0x30
    v_bitop3_b32 v51, v51, v168, v168 bitop3:0x30
    buffer_load_dwordx4 v[92:95], v13, s[8:11], s41 offen offset:3840
    v_bitop3_b32 v54, v54, v161, v161 bitop3:0x30
    v_bitop3_b32 v55, v55, v169, v169 bitop3:0x30
    v_bitop3_b32 v58, v58, v162, v162 bitop3:0x30
    v_bitop3_b32 v59, v59, v170, v170 bitop3:0x30
    v_bitop3_b32 v62, v62, v163, v163 bitop3:0x30
    v_bitop3_b32 v63, v63, v171, v171 bitop3:0x30
    s_waitcnt lgkmcnt(0)
    s_barrier
    s_waitcnt vmcnt(4)
    v_and_b32 v160, v176, v64
    v_and_b32 v161, v176, v68
    v_and_b32 v162, v176, v72
    v_and_b32 v163, v176, v76
    v_and_b32 v168, v176, v65
    v_and_b32 v169, v176, v69
    v_and_b32 v170, v176, v73
    v_and_b32_e64 v171, v176, v77
    ds_write_b128 v14, v[48:51] offset:16384
    v_pk_max_u16 v164, v160, v161
    v_pk_max_u16 v172, v168, v169
    v_pk_min_u16 v165, v160, v161
    v_pk_min_u16 v173, v168, v169
    v_pk_max_u16 v166, v162, v163
    v_pk_max_u16 v174, v170, v171
    v_pk_min_u16 v167, v162, v163
    v_pk_min_u16 v175, v170, v171
    v_pk_max_u16 v164, v164, v167
    v_pk_max_u16 v172, v172, v175
    v_pk_max_u16 v166, v166, v165
    v_pk_max_u16 v174, v174, v173
    v_pk_min_u16 v164, v164, v166
    v_pk_min_u16 v172, v172, v174
    v_pk_sub_i16 v160, v160, v164
    v_pk_sub_i16 v168, v168, v172
    v_pk_sub_i16 v161, v161, v164
    v_pk_sub_i16 v169, v169, v172
    v_pk_sub_i16 v162, v162, v164
    v_pk_sub_i16 v170, v170, v172
    v_pk_sub_i16 v163, v163, v164
    v_pk_sub_i16 v171, v171, v172
    ds_write_b128 v15, v[52:55] offset:16384
    v_pk_ashrrev_i16 v160, 15, v160 op_sel_hi:[0,1]
    v_pk_ashrrev_i16 v168, 15, v168 op_sel_hi:[0,1]
    v_pk_ashrrev_i16 v161, 15, v161 op_sel_hi:[0,1]
    v_pk_ashrrev_i16 v169, 15, v169 op_sel_hi:[0,1]
    v_pk_ashrrev_i16 v162, 15, v162 op_sel_hi:[0,1]
    v_pk_ashrrev_i16 v170, 15, v170 op_sel_hi:[0,1]
    v_pk_ashrrev_i16 v163, 15, v163 op_sel_hi:[0,1]
    v_pk_ashrrev_i16 v171, 15, v171 op_sel_hi:[0,1]
    v_bitop3_b32 v64, v64, v160, v160 bitop3:0x30
    v_bitop3_b32 v65, v65, v168, v168 bitop3:0x30
    v_bitop3_b32 v68, v68, v161, v161 bitop3:0x30
    v_bitop3_b32 v69, v69, v169, v169 bitop3:0x30
    v_bitop3_b32 v72, v72, v162, v162 bitop3:0x30
    v_bitop3_b32 v73, v73, v170, v170 bitop3:0x30
    v_bitop3_b32 v76, v76, v163, v163 bitop3:0x30
    v_bitop3_b32 v77, v77, v171, v171 bitop3:0x30
    v_and_b32 v160, v176, v66
    v_and_b32 v161, v176, v70
    v_and_b32 v162, v176, v74
    v_and_b32 v163, v176, v78
    v_and_b32 v168, v176, v67
    v_and_b32 v169, v176, v71
    ds_write_b128 v14, v[56:59] offset:16512
    v_and_b32 v170, v176, v75
    v_and_b32 v171, v176, v79
    v_pk_max_u16 v164, v160, v161
    v_pk_max_u16 v172, v168, v169
    v_pk_min_u16 v165, v160, v161
    v_pk_min_u16 v173, v168, v169
    v_pk_max_u16 v166, v162, v163
    v_pk_max_u16 v174, v170, v171
    v_pk_min_u16 v167, v162, v163
    v_pk_min_u16 v175, v170, v171
    v_pk_max_u16 v164, v164, v167
    v_pk_max_u16 v172, v172, v175
    v_pk_max_u16 v166, v166, v165
    v_pk_max_u16 v174, v174, v173
    v_pk_min_u16 v164, v164, v166
    v_pk_min_u16 v172, v172, v174
    v_pk_sub_i16 v160, v160, v164
    v_pk_sub_i16 v168, v168, v172
    v_pk_sub_i16 v161, v161, v164
    v_pk_sub_i16 v169, v169, v172
    v_pk_sub_i16 v162, v162, v164
    v_pk_sub_i16 v170, v170, v172
    ds_write_b128 v15, v[60:63] offset:16512
    v_pk_sub_i16 v163, v163, v164
    v_pk_sub_i16 v171, v171, v172
    v_pk_ashrrev_i16 v160, 15, v160 op_sel_hi:[0,1]
    v_pk_ashrrev_i16 v168, 15, v168 op_sel_hi:[0,1]
    v_pk_ashrrev_i16 v161, 15, v161 op_sel_hi:[0,1]
    v_pk_ashrrev_i16 v169, 15, v169 op_sel_hi:[0,1]
    v_pk_ashrrev_i16 v162, 15, v162 op_sel_hi:[0,1]
    v_pk_ashrrev_i16 v170, 15, v170 op_sel_hi:[0,1]
    v_pk_ashrrev_i16 v163, 15, v163 op_sel_hi:[0,1]
    v_pk_ashrrev_i16 v171, 15, v171 op_sel_hi:[0,1]
    v_bitop3_b32 v66, v66, v160, v160 bitop3:0x30
    v_bitop3_b32 v67, v67, v168, v168 bitop3:0x30
    v_bitop3_b32 v70, v70, v161, v161 bitop3:0x30
    v_bitop3_b32 v71, v71, v169, v169 bitop3:0x30
    v_bitop3_b32 v74, v74, v162, v162 bitop3:0x30
    v_bitop3_b32 v75, v75, v170, v170 bitop3:0x30
    v_bitop3_b32 v78, v78, v163, v163 bitop3:0x30
    v_bitop3_b32 v79, v79, v171, v171 bitop3:0x30
    s_waitcnt lgkmcnt(0)
    s_barrier
    s_cmp_ge_u32 s38, 2
    s_cbranch_scc1 L_pskip
    s_waitcnt vmcnt(0)
    v_and_b32 v160, v176, v80
    v_and_b32 v161, v176, v84
    v_and_b32 v162, v176, v88
    v_and_b32 v163, v176, v92
    v_and_b32 v168, v176, v81
    v_and_b32 v169, v176, v85
    v_and_b32 v170, v176, v89
    v_and_b32_e64 v171, v176, v93
    ds_write_b128 v14, v[64:67] offset:32768
    v_pk_max_u16 v164, v160, v161
    v_pk_max_u16 v172, v168, v169
    v_pk_min_u16 v165, v160, v161
    v_pk_min_u16 v173, v168, v169
    v_pk_max_u16 v166, v162, v163
    v_pk_max_u16 v174, v170, v171
    v_pk_min_u16 v167, v162, v163
    v_pk_min_u16 v175, v170, v171
    v_pk_max_u16 v164, v164, v167
    v_pk_max_u16 v172, v172, v175
    v_pk_max_u16 v166, v166, v165
    v_pk_max_u16 v174, v174, v173
    v_pk_min_u16 v164, v164, v166
    v_pk_min_u16 v172, v172, v174
    v_pk_sub_i16 v160, v160, v164
    v_pk_sub_i16 v168, v168, v172
    v_pk_sub_i16 v161, v161, v164
    v_pk_sub_i16 v169, v169, v172
    v_pk_sub_i16 v162, v162, v164
    v_pk_sub_i16 v170, v170, v172
    v_pk_sub_i16 v163, v163, v164
    v_pk_sub_i16 v171, v171, v172
    ds_write_b128 v15, v[68:71] offset:32768
    v_pk_ashrrev_i16 v160, 15, v160 op_sel_hi:[0,1]
    v_pk_ashrrev_i16 v168, 15, v168 op_sel_hi:[0,1]
    v_pk_ashrrev_i16 v161, 15, v161 op_sel_hi:[0,1]
    v_pk_ashrrev_i16 v169, 15, v169 op_sel_hi:[0,1]
    v_pk_ashrrev_i16 v162, 15, v162 op_sel_hi:[0,1]
    v_pk_ashrrev_i16 v170, 15, v170 op_sel_hi:[0,1]
    v_pk_ashrrev_i16 v163, 15, v163 op_sel_hi:[0,1]
    v_pk_ashrrev_i16 v171, 15, v171 op_sel_hi:[0,1]
    v_bitop3_b32 v80, v80, v160, v160 bitop3:0x30
    v_bitop3_b32 v81, v81, v168, v168 bitop3:0x30
    v_bitop3_b32 v84, v84, v161, v161 bitop3:0x30
    v_bitop3_b32 v85, v85, v169, v169 bitop3:0x30
    v_bitop3_b32 v88, v88, v162, v162 bitop3:0x30
    v_bitop3_b32 v89, v89, v170, v170 bitop3:0x30
    v_bitop3_b32 v92, v92, v163, v163 bitop3:0x30
    v_bitop3_b32 v93, v93, v171, v171 bitop3:0x30
    v_and_b32 v160, v176, v82
    v_and_b32 v161, v176, v86
    v_and_b32 v162, v176, v90
    v_and_b32 v163, v176, v94
    v_and_b32 v168, v176, v83
    v_and_b32 v169, v176, v87
    ds_write_b128 v14, v[72:75] offset:32896
    v_and_b32 v170, v176, v91
    v_and_b32 v171, v176, v95
    v_pk_max_u16 v164, v160, v161
    v_pk_max_u16 v172, v168, v169
    v_pk_min_u16 v165, v160, v161
    v_pk_min_u16 v173, v168, v169
    v_pk_max_u16 v166, v162, v163
    v_pk_max_u16 v174, v170, v171
    v_pk_min_u16 v167, v162, v163
    v_pk_min_u16 v175, v170, v171
    v_pk_max_u16 v164, v164, v167
    v_pk_max_u16 v172, v172, v175
    v_pk_max_u16 v166, v166, v165
    v_pk_max_u16 v174, v174, v173
    v_pk_min_u16 v164, v164, v166
    v_pk_min_u16 v172, v172, v174
    v_pk_sub_i16 v160, v160, v164
    v_pk_sub_i16 v168, v168, v172
    v_pk_sub_i16 v161, v161, v164
    v_pk_sub_i16 v169, v169, v172
    v_pk_sub_i16 v162, v162, v164
    v_pk_sub_i16 v170, v170, v172
    ds_write_b128 v15, v[76:79] offset:32896
    v_pk_sub_i16 v163, v163, v164
    v_pk_sub_i16 v171, v171, v172
    v_pk_ashrrev_i16 v160, 15, v160 op_sel_hi:[0,1]
    v_pk_ashrrev_i16 v168, 15, v168 op_sel_hi:[0,1]
    v_pk_ashrrev_i16 v161, 15, v161 op_sel_hi:[0,1]
    v_pk_ashrrev_i16 v169, 15, v169 op_sel_hi:[0,1]
    v_pk_ashrrev_i16 v162, 15, v162 op_sel_hi:[0,1]
    v_pk_ashrrev_i16 v170, 15, v170 op_sel_hi:[0,1]
    v_pk_ashrrev_i16 v163, 15, v163 op_sel_hi:[0,1]
    v_pk_ashrrev_i16 v171, 15, v171 op_sel_hi:[0,1]
    v_bitop3_b32 v82, v82, v160, v160 bitop3:0x30
    v_bitop3_b32 v83, v83, v168, v168 bitop3:0x30
    v_bitop3_b32 v86, v86, v161, v161 bitop3:0x30
    v_bitop3_b32 v87, v87, v169, v169 bitop3:0x30
    v_bitop3_b32 v90, v90, v162, v162 bitop3:0x30
    v_bitop3_b32 v91, v91, v170, v170 bitop3:0x30
    v_bitop3_b32 v94, v94, v163, v163 bitop3:0x30
    v_bitop3_b32 v95, v95, v171, v171 bitop3:0x30
    s_waitcnt lgkmcnt(0)
    s_barrier
    ds_write_b128 v14, v[80:83] offset:0
    ds_write_b128 v15, v[84:87] offset:0
    ds_write_b128 v14, v[88:91] offset:128
    ds_write_b128 v15, v[92:95] offset:128
    s_waitcnt lgkmcnt(0)
    s_barrier
    s_endpgm
L_pskip:
    s_nop 0
    ds_write_b128 v14, v[64:67] offset:32768
    ds_write_b128 v15, v[68:71] offset:32768
    ds_write_b128 v14, v[72:75] offset:32896
    ds_write_b128 v15, v[76:79] offset:32896
    s_waitcnt lgkmcnt(0)
    s_barrier
    s_barrier
L_end:
    s_endpgm
.section .rodata,"a"
.p2align 6
.amdhsa_kernel standalone__structured_sparse_n_m__ragged_kernel
  .amdhsa_next_free_vgpr 256
  .amdhsa_next_free_sgpr 102
  .amdhsa_accum_offset 256
  .amdhsa_group_segment_fixed_size 0
  .amdhsa_kernarg_size 48
  .amdhsa_user_sgpr_count 2
  .amdhsa_user_sgpr_kernarg_segment_ptr 1
  .amdhsa_system_sgpr_workgroup_id_x 1
.end_amdhsa_kernel
```
